```python
import torch

def _softmax(x, axis=-1):
    return torch.softmax(x, dim=axis)
def _gelu(x):
    return torch.nn.functional.gelu(x, approximate="tanh")
def _silu(x):
    return torch.nn.functional.silu(x)
def _sigmoid(x):
    return torch.sigmoid(x)
def _layernorm(x, axis=-1, eps=1e-5):
    m = x.mean(dim=axis, keepdim=True)
    v = x.var(dim=axis, keepdim=True, unbiased=False)
    return (x - m) / torch.sqrt(v + eps)
def _scatter_add(tgt, idx, src, axis=0):
    return tgt.clone().index_add_(axis, idx, src)
def _segment_sum(src, seg, n):
    out = torch.zeros((n,) + src.shape[1:], dtype=src.dtype)
    return out.index_add_(0, seg, src)
def _pad(x, pw):
    flat = tuple(v for pair in reversed(pw) for v in pair)
    return torch.nn.functional.pad(x, flat)

kernel_name = 'gated_mix__ssm_conv_h3__dense_activation_mish__prompt'

def setup_inputs():

    _w = (lambda a: (lambda t: t.to(torch.bfloat16) if t.is_floating_point() else t)(torch.as_tensor(a)))
    def _A_setup():
        B, S, D = 1, 2048, 448
        ks = 4
        return {
            "q": _w((lambda *s: torch.randn(*s, dtype=torch.bfloat16) * 0.05)(B, S, D)),
            "k": _w((lambda *s: torch.randn(*s, dtype=torch.bfloat16) * 0.4)(B, S, D)),
            "v": _w((lambda *s: torch.randn(*s, dtype=torch.bfloat16) * 0.2)(B, S, D)),
            "shift_k": _w((lambda *s: torch.randn(*s, dtype=torch.bfloat16) * 0.4)(D, ks) * 0.5),
            "ssm_k": _w((lambda *s: torch.randn(*s, dtype=torch.bfloat16) * 0.4)(D, S) * (1.0 / S ** 0.5)),
            "ssm_D": _w((lambda *s: torch.randn(*s, dtype=torch.bfloat16) * 0.2)(D)),
        }
    _A_in = _A_setup()

    def _B_setup():
        B, S, D, F = 1, 2048, 448, 1792
        return {
            "x": _w((lambda *s: torch.randn(*s, dtype=torch.bfloat16) * 0.05)(B, S, D)),
            "w1": _w((lambda *s: torch.randn(*s, dtype=torch.bfloat16) * 3.2)(D, F) * (D ** -0.5)),
            "b1": _w((lambda *s: torch.randn(*s, dtype=torch.bfloat16) * 0.05)(F)),
            "w2": _w((lambda *s: torch.randn(*s, dtype=torch.bfloat16) * 0.05)(F, D) * (F ** -0.5)),
        }
    _B_in = _B_setup()

    return {
        "A_q": _A_in["q"],
        "A_k": _A_in["k"],
        "A_v": _A_in["v"],
        "A_shift_k": _A_in["shift_k"],
        "A_ssm_k": _A_in["ssm_k"],
        "A_ssm_D": _A_in["ssm_D"],
        "B_x": _B_in["x"],
        "B_w1": _B_in["w1"],
        "B_b1": _B_in["b1"],
        "B_w2": _B_in["w2"],
        "gate_w": _w((lambda *s: torch.randn(*s, dtype=torch.bfloat16) * 0.05)(448) * 16.0),
    }

def reference(A_q, A_k, A_v, A_shift_k, A_ssm_k, A_ssm_D, B_x, B_w1, B_b1, B_w2, gate_w):
    def _A_ref(q, k, v, shift_k, ssm_k, ssm_D):
        B, S, D = q.shape
        ks = shift_k.shape[-1]
        k_pad = _pad(k, ((0, 0), (ks - 1, 0), (0, 0)))
        k_shift = torch.zeros_like(k)
        for t in range(ks):
            k_shift = k_shift + k_pad[:, t:t + S, :] * shift_k[:, ks - 1 - t][None, None, :]
        kv = k_shift * v
        L = 2 * S
        kv_pad = _pad(kv, ((0, 0), (0, S), (0, 0)))
        kf_pad = _pad(ssm_k, ((0, 0), (0, S)))
        kv_f = (lambda x, axes=(-2,-1): torch.fft.rfft2(x.float(), dim=axes))(kv_pad[:, None, :, :], axes=(1, 2))
        kf_f = (lambda x, axes=(-2,-1): torch.fft.rfft2(x.float(), dim=axes))(kf_pad[:, None, :], axes=(1, 2))
        kf_f = (lambda x, *d: x.permute(*d))(kf_f, 1, 2, 0)
        y_f = kv_f * kf_f[None, :, :, :]
        y = (lambda x, s, axes=(-2,-1): torch.fft.irfft2(x, s=s, dim=axes).to(torch.bfloat16))(y_f, (1, L), axes=(1, 2))[:, 0, :S, :]
        y = y + kv * ssm_D[None, None, :]
        return q * y

    def _B_ref(x, w1, b1, w2):
        h = torch.einsum("bsd,df->bsf", x, w1) + b1
        sp = torch.log1p(torch.exp(-torch.abs(h))) + torch.where(h > 0, h, torch.zeros_like(h))
        act = h * torch.tanh(sp)
        return torch.einsum("bsf,fd->bsd", act, w2)

    x = A_q
    g = _sigmoid((x * gate_w).sum(-1, keepdims=True))
    a = _A_ref(x, A_k, A_v, A_shift_k, A_ssm_k, A_ssm_D)
    b = _B_ref(x, B_w1, B_b1, B_w2)
    return g * a + (1 - g) * b
```

```asm
; @launch grid=(256,1,1) block=(512,1,1) lds=162432
.amdgcn_target "amdgcn-amd-amdhsa--gfx950"
.text
.globl gated_mix__ssm_conv_h3__dense_activation_mish__prompt_kernel
.p2align 8
.type gated_mix__ssm_conv_h3__dense_activation_mish__prompt_kernel,@function
gated_mix__ssm_conv_h3__dense_activation_mish__prompt_kernel:
    s_cmp_ge_u32 s2, 256
    s_cbranch_scc1 L_END
    s_load_dwordx16 s[16:31], s[0:1], 0
    s_load_dwordx8 s[32:39], s[0:1], 64
    s_load_dwordx4 s[40:43], s[0:1], 96
    v_lshrrev_b32 v1, 6, v0
    v_and_b32 v127, 63, v0
    v_readfirstlane_b32 s11, v1
    s_and_b32 s3, s2, 7
    s_lshr_b32 s7, s2, 3
    s_sub_u32 s13, s7, 4
    s_mul_i32 s14, s13, 37
    s_lshr_b32 s14, s14, 8
    s_mul_i32 s15, s14, 7
    s_sub_u32 s5, s13, s15
    s_lshl_b32 s4, s3, 2
    s_add_u32 s4, s4, s14
    v_lshrrev_b32 v126, 4, v127
    s_cmp_ge_u32 s11, 4
    s_cbranch_scc1 L_CROLE
    s_cmp_lt_u32 s7, 4
    s_cbranch_scc1 L_PROLE
    s_setprio 2
    s_lshl_b32 s12, s4, 2
    s_add_u32 s12, s12, s11
    s_mul_i32 s78, s12, 14336
    s_lshl_b32 s79, s11, 11
    v_lshrrev_b32 v80, 3, v127
    v_mul_u32_u24 v80, 896, v80
    v_and_b32 v81, 7, v127
    v_xor_b32 v82, v81, v126
    v_lshl_add_u32 v112, v82, 4, v80
    v_xor_b32 v82, 4, v82
    v_lshl_add_u32 v113, v82, 4, v80
    v_add_u32 v113, 6144, v113
    s_lshl_b32 s12, s11, 2
    v_mov_b32 v121, s12
    v_mov_b32 v83, 0
    ds_write_b32 v121, v83 offset:0
    s_mul_i32 s76, s11, 15360
    s_add_u32 s76, s76, 57600
    s_lshl_b32 s80, s5, 9
    s_lshl_b32 s12, s11, 6
    s_add_u32 s80, s80, s12
    v_lshrrev_b32 v84, 2, v127
    v_mul_u32_u24 v108, 3584, v84
    v_and_b32 v85, 3, v127
    v_lshl_add_u32 v108, v85, 4, v108
    v_lshlrev_b32 v125, 4, v127
    v_lshrrev_b32 v86, 5, v127
    v_lshlrev_b32 v87, 4, v86
    s_mul_i32 s13, s11, 224
    s_waitcnt lgkmcnt(0)
    s_mov_b32 s48, s16
    s_and_b32 s49, s17, 0xffff
    s_mov_b32 s50, 0x1c0000
    s_mov_b32 s51, 0x20000
    s_add_u32 m0, s79, 0x100
    s_nop 0
    buffer_load_dwordx4 v112, s[48:51], s78 offen offset:0 lds
    buffer_load_dwordx4 v113, s[48:51], s78 offen offset:1024 lds
    s_mov_b32 s64, s36
    s_and_b32 s65, s37, 0xffff
    s_mov_b32 s66, 0x380
    s_mov_b32 s67, 0x20000
    s_add_u32 m0, s13, 161536
    s_mov_b64 exec, 0x3fff
    buffer_load_dwordx4 v125, s[64:67], s13 offen lds
    s_mov_b64 exec, -1
    s_add_u32 m0, s79, 0x2080
    s_nop 0
    buffer_load_dwordx4 v112, s[48:51], s78 offen offset:128 lds
    buffer_load_dwordx4 v113, s[48:51], s78 offen offset:1152 lds
    s_add_u32 m0, s79, 0x4000
    s_nop 0
    buffer_load_dwordx4 v112, s[48:51], s78 offen offset:256 lds
    buffer_load_dwordx4 v113, s[48:51], s78 offen offset:1280 lds
    s_barrier
    s_add_u32 m0, s79, 0x5f80
    s_nop 0
    buffer_load_dwordx4 v112, s[48:51], s78 offen offset:384 lds
    buffer_load_dwordx4 v113, s[48:51], s78 offen offset:1408 lds
    s_mov_b32 s60, s32
    s_and_b32 s61, s33, 0xffff
    s_mov_b32 s62, 0xe00
    s_mov_b32 s63, 0x20000
    buffer_load_dwordx4 v[64:67], v87, s[60:63], s80 offen offset:0
    buffer_load_dwordx4 v[68:71], v87, s[60:63], s80 offen offset:32
    buffer_load_dwordx4 v[72:75], v87, s[60:63], s80 offen offset:256
    buffer_load_dwordx4 v[76:79], v87, s[60:63], s80 offen offset:288
    s_mov_b32 s52, s30
    s_and_b32 s53, s31, 0xffff
    s_mov_b32 s54, 0x188000
    s_mov_b32 s55, 0x20000
    v_add_u32 v109, 56320, v108
    v_add_u32 v110, 112640, v108
    v_add_u32 v111, 168960, v108
    s_mov_b32 s44, s42
    s_and_b32 s45, s43, 0xffff
    s_mov_b32 s46, 0x3000000
    s_mov_b32 s47, 0x20000
    s_sub_u32 s56, s34, 4096
    s_subb_u32 s57, s35, 0
    s_and_b32 s57, s57, 0xffff
    s_mov_b32 s58, 0x189000
    s_mov_b32 s59, 0x20000
    s_waitcnt vmcnt(12)
    s_add_u32 m0, s79, 0x7f00
    s_nop 0
    buffer_load_dwordx4 v112, s[48:51], s78 offen offset:512 lds
    s_waitcnt vmcnt(12)
    buffer_load_dwordx4 v113, s[48:51], s78 offen offset:1536 lds
    v_and_b32 v80, 31, v127
    v_lshlrev_b32 v82, 7, v80
    v_bfe_u32 v83, v127, 1, 3
    v_xor_b32 v83, v83, v86
    v_lshl_add_u32 v82, v83, 4, v82
    v_add_u32 v104, 256, v82
    v_xor_b32 v105, 32, v104
    v_xor_b32 v106, 64, v104
    v_xor_b32 v107, 96, v104
    s_waitcnt vmcnt(11)
    s_add_u32 m0, s79, 0x9e80
    s_nop 0
    buffer_load_dwordx4 v112, s[48:51], s78 offen offset:640 lds
    s_waitcnt vmcnt(11)
    buffer_load_dwordx4 v113, s[48:51], s78 offen offset:1664 lds
    v_bfe_u32 v82, v127, 2, 2
    v_lshl_add_u32 v82, v86, 3, v82
    v_and_b32 v83, 1, v126
    v_lshl_add_u32 v82, v82, 1, v83
    v_and_b32 v83, 1, v127
    v_lshl_add_u32 v82, v82, 1, v83
    v_bfe_u32 v83, v127, 1, 1
    v_lshl_add_u32 v82, v82, 1, v83
    v_lshl_add_u32 v120, v82, 3, s76
    v_lshlrev_b32 v122, 2, v85
    s_mov_b32 s74, 0x3fb8aa3b
    s_waitcnt vmcnt(11)
    s_add_u32 m0, s79, 0xbe00
    s_nop 0
    buffer_load_dwordx4 v112, s[48:51], s78 offen offset:768 lds
    s_waitcnt vmcnt(11)
    buffer_load_dwordx4 v113, s[48:51], s78 offen offset:1792 lds
    s_waitcnt vmcnt(6)
    v_lshlrev_b32 v16, 16, v64
    v_and_b32 v17, 0xffff0000, v64
    v_lshlrev_b32 v18, 16, v65
    v_and_b32 v19, 0xffff0000, v65
    s_add_u32 m0, s76, 0x0
    s_nop 0
    buffer_load_dwordx4 v108, s[52:55], s80 offen lds
    v_lshlrev_b32 v20, 16, v66
    v_and_b32 v21, 0xffff0000, v66
    v_lshlrev_b32 v22, 16, v67
    v_and_b32 v23, 0xffff0000, v67
    buffer_load_dwordx4 v109, s[52:55], s80 offen offset:1024 lds
    v_lshlrev_b32 v24, 16, v68
    v_and_b32 v25, 0xffff0000, v68
    v_lshlrev_b32 v26, 16, v69
    v_and_b32 v27, 0xffff0000, v69
    s_waitcnt vmcnt(7)
    buffer_load_dwordx4 v110, s[52:55], s80 offen offset:2048 lds
    v_lshlrev_b32 v28, 16, v70
    v_and_b32 v29, 0xffff0000, v70
    v_lshlrev_b32 v30, 16, v71
    v_and_b32 v31, 0xffff0000, v71
    s_waitcnt vmcnt(7)
    buffer_load_dwordx4 v111, s[52:55], s80 offen offset:3072 lds
    v_lshlrev_b32 v48, 16, v72
    v_and_b32 v49, 0xffff0000, v72
    v_lshlrev_b32 v50, 16, v73
    v_and_b32 v51, 0xffff0000, v73
    s_waitcnt vmcnt(7)
    s_add_u32 m0, s76, 0x1000
    s_add_u32 s80, s80, 229376
    buffer_load_dwordx4 v108, s[52:55], s80 offen lds
    v_lshlrev_b32 v52, 16, v74
    v_and_b32 v53, 0xffff0000, v74
    v_lshlrev_b32 v54, 16, v75
    v_and_b32 v55, 0xffff0000, v75
    s_waitcnt vmcnt(7)
    buffer_load_dwordx4 v109, s[52:55], s80 offen offset:1024 lds
    v_lshlrev_b32 v56, 16, v76
    v_and_b32 v57, 0xffff0000, v76
    v_lshlrev_b32 v58, 16, v77
    v_and_b32 v59, 0xffff0000, v77
    s_waitcnt vmcnt(7)
    buffer_load_dwordx4 v110, s[52:55], s80 offen offset:2048 lds
    v_lshlrev_b32 v60, 16, v78
    v_and_b32 v61, 0xffff0000, v78
    v_lshlrev_b32 v62, 16, v79
    v_and_b32 v63, 0xffff0000, v79
    s_waitcnt vmcnt(7)
    buffer_load_dwordx4 v111, s[52:55], s80 offen offset:3072 lds
    v_mov_b32 v95, 1
    ds_write_b32 v121, v95 offset:0
    v_and_b32 v93, 28, v127
    ds_read_b32 v123, v93 offset:0
    s_waitcnt lgkmcnt(0)
    v_cmp_gt_u32 vcc, 1, v123
    s_cbranch_vccz CK_1
    s_mov_b32 s75, 65536
LS_2:
    ds_read_b32 v123, v93 offset:0
    s_sub_u32 s75, s75, 1
    s_cmp_eq_u32 s75, 0
    s_cbranch_scc1 LD_3
    s_waitcnt lgkmcnt(0)
    v_cmp_gt_u32 vcc, 1, v123
    s_cbranch_vccnz LS_2
LD_3:
    s_waitcnt lgkmcnt(0)
CK_1:
    s_waitcnt vmcnt(7)
    ds_read_b64_tr_b16 a[64:65], v120 offset:0
    ds_read_b64_tr_b16 a[66:67], v120 offset:256
    ds_read_b128 a[68:71], v104 offset:0
    ds_read_b128 a[72:75], v104 offset:4096
    s_waitcnt lgkmcnt(1)
    v_mfma_f32_32x32x16_bf16 v[0:15], a[64:67], a[68:71], v[16:31]
    s_waitcnt vmcnt(5)
    s_add_u32 m0, s76, 0x2000
    s_add_u32 s80, s80, 229376
    buffer_load_dwordx4 v108, s[52:55], s80 offen lds
    buffer_load_dwordx4 v109, s[52:55], s80 offen offset:1024 lds
    buffer_load_dwordx4 v110, s[52:55], s80 offen offset:2048 lds
    s_lshr_b32 s92, s11, 1
    s_mul_i32 s77, s11, 14336
    s_waitcnt lgkmcnt(0)
    v_mfma_f32_32x32x16_bf16 v[16:31], a[64:67], a[72:75], v[16:31]
    ds_read_b64_tr_b16 a[76:77], v120 offset:1024
    ds_read_b64_tr_b16 a[78:79], v120 offset:1280
    ds_read_b128 a[80:83], v105 offset:0
    ds_read_b128 a[84:87], v105 offset:4096
    ds_read_b64_tr_b16 a[88:89], v120 offset:2048
    ds_read_b64_tr_b16 a[90:91], v120 offset:2304
    ds_read_b128 a[92:95], v106 offset:0
    ds_read_b128 a[96:99], v106 offset:4096
    s_add_u32 s77, s77, 256
    s_sub_u32 s90, s76, s77
    s_waitcnt lgkmcnt(5)
    v_mfma_f32_32x32x16_bf16 v[0:15], a[76:79], a[80:83], v[0:15]
    s_waitcnt vmcnt(7)
    buffer_load_dwordx4 v111, s[52:55], s80 offen offset:3072 lds
    v_subrev_u32 v91, s90, v120
    v_lshrrev_b32 v96, 2, v127
    s_waitcnt lgkmcnt(4)
    v_mfma_f32_32x32x16_bf16 v[16:31], a[76:79], a[84:87], v[16:31]
    ds_read_b64_tr_b16 a[100:101], v120 offset:3072
    ds_read_b64_tr_b16 a[102:103], v120 offset:3328
    ds_read_b128 a[104:107], v107 offset:0
    ds_read_b128 a[108:111], v107 offset:4096
    v_mul_u32_u24 v96, 896, v96
    v_lshl_add_u32 v96, v122, 2, v96
    s_waitcnt lgkmcnt(5)
    v_mfma_f32_32x32x16_bf16 v[0:15], a[88:91], a[92:95], v[0:15]
    s_waitcnt vmcnt(7)
    s_add_u32 m0, s76, 0x3000
    s_add_u32 s80, s80, 229376
    buffer_load_dwordx4 v108, s[52:55], s80 offen lds
    s_and_b32 s90, s11, 1
    s_lshl_b32 s90, s90, 6
    s_waitcnt lgkmcnt(4)
    v_mfma_f32_32x32x16_bf16 v[16:31], a[88:91], a[96:99], v[16:31]
    ds_read_b64_tr_b16 a[112:113], v120 offset:4096
    ds_read_b64_tr_b16 a[114:115], v120 offset:4352
    ds_read_b128 a[116:119], v104 offset:8192
    ds_read_b128 a[120:123], v104 offset:12288
    s_mul_i32 s91, s92, 14336
    s_add_u32 s93, s90, s91
    s_waitcnt lgkmcnt(5)
    v_mfma_f32_32x32x16_bf16 v[0:15], a[100:103], a[104:107], v[0:15]
    s_waitcnt vmcnt(7)
    buffer_load_dwordx4 v109, s[52:55], s80 offen offset:1024 lds
    s_add_u32 s93, s93, 4096
    v_add_u32 v112, s93, v96
    s_waitcnt lgkmcnt(4)
    v_mfma_f32_32x32x16_bf16 v[16:31], a[100:103], a[108:111], v[16:31]
    ds_read_b64_tr_b16 a[64:65], v120 offset:5120
    ds_read_b64_tr_b16 a[66:67], v120 offset:5376
    ds_read_b128 a[68:71], v105 offset:8192
    ds_read_b128 a[72:75], v105 offset:12288
    s_sub_u32 s93, s90, s91
    s_add_u32 s93, s93, 17408
    s_waitcnt lgkmcnt(5)
    v_mfma_f32_32x32x16_bf16 v[0:15], a[112:115], a[116:119], v[0:15]
    s_waitcnt vmcnt(7)
    buffer_load_dwordx4 v110, s[52:55], s80 offen offset:2048 lds
    v_add_u32 v113, s93, v96
    v_add_u32 v114, 26624, v112
    s_waitcnt lgkmcnt(4)
    v_mfma_f32_32x32x16_bf16 v[16:31], a[112:115], a[120:123], v[16:31]
    ds_read_b64_tr_b16 a[76:77], v120 offset:6144
    ds_read_b64_tr_b16 a[78:79], v120 offset:6400
    ds_read_b128 a[80:83], v106 offset:8192
    ds_read_b128 a[84:87], v106 offset:12288
    v_add_u32 v115, 26624, v113
    s_lshl_b32 s90, s90, 2
    s_waitcnt lgkmcnt(5)
    v_mfma_f32_32x32x16_bf16 v[0:15], a[64:67], a[68:71], v[0:15]
    s_waitcnt vmcnt(7)
    s_add_u32 m0, s76, 0xfffff400
    v_lshl_add_u32 v124, v122, 2, s90
    buffer_load_dwordx4 v111, s[52:55], s80 offen offset:3072 lds
    v_bfe_u32 v96, v127, 2, 2
    v_lshl_add_u32 v124, v96, 11, v124
    s_waitcnt lgkmcnt(4)
    v_mfma_f32_32x32x16_bf16 v[16:31], a[64:67], a[72:75], v[16:31]
    ds_read_b64_tr_b16 a[88:89], v120 offset:7168
    ds_read_b64_tr_b16 a[90:91], v120 offset:7424
    ds_read_b128 a[92:95], v107 offset:8192
    ds_read_b128 a[96:99], v107 offset:12288
    v_and_b32 v96, 1, v126
    v_lshl_add_u32 v124, v96, 9, v124
    s_waitcnt lgkmcnt(5)
    v_mfma_f32_32x32x16_bf16 v[0:15], a[76:79], a[80:83], v[0:15]
    s_waitcnt vmcnt(7)
    s_add_u32 m0, s76, 0x400
    s_add_u32 s80, s80, 229376
    buffer_load_dwordx4 v108, s[52:55], s80 offen lds
    v_lshrrev_b32 v96, 5, v127
    v_lshl_add_u32 v124, v96, 6, v124
    s_waitcnt lgkmcnt(4)
    v_mfma_f32_32x32x16_bf16 v[16:31], a[76:79], a[84:87], v[16:31]
    ds_read_b64_tr_b16 a[100:101], v120 offset:8192
    ds_read_b64_tr_b16 a[102:103], v120 offset:8448
    ds_read_b128 a[104:107], v104 offset:16384
    ds_read_b128 a[108:111], v104 offset:20480
    v_lshl_add_u32 v92, v96, 6, v125
    v_add_u32 v92, s77, v92
    s_waitcnt lgkmcnt(5)
    v_mfma_f32_32x32x16_bf16 v[0:15], a[88:91], a[92:95], v[0:15]
    s_waitcnt vmcnt(7)
    buffer_load_dwordx4 v109, s[52:55], s80 offen offset:1024 lds
    v_add_u32 v90, s76, v125
    s_lshl_b32 s90, s92, 10
    s_waitcnt lgkmcnt(4)
    v_mfma_f32_32x32x16_bf16 v[16:31], a[88:91], a[96:99], v[16:31]
    ds_read_b64_tr_b16 a[112:113], v120 offset:9216
    ds_read_b64_tr_b16 a[114:115], v120 offset:9472
    ds_read_b128 a[116:119], v105 offset:16384
    ds_read_b128 a[120:123], v105 offset:20480
    s_add_u32 s91, s90, 57600
    v_add_u32 v88, s91, v125
    s_waitcnt lgkmcnt(5)
    v_mfma_f32_32x32x16_bf16 v[0:15], a[100:103], a[104:107], v[0:15]
    s_waitcnt vmcnt(7)
    buffer_load_dwordx4 v110, s[52:55], s80 offen offset:2048 lds
    s_sub_u32 s91, 58624, s90
    v_add_u32 v89, s91, v125
    s_waitcnt lgkmcnt(4)
    v_mfma_f32_32x32x16_bf16 v[16:31], a[100:103], a[108:111], v[16:31]
    ds_read_b64_tr_b16 a[64:65], v120 offset:10240
    ds_read_b64_tr_b16 a[66:67], v120 offset:10496
    ds_read_b128 a[68:71], v106 offset:16384
    ds_read_b128 a[72:75], v106 offset:20480
    s_mul_i32 s93, s5, 229376
    s_lshl_b32 s90, s5, 7
    s_waitcnt lgkmcnt(5)
    v_mfma_f32_32x32x16_bf16 v[0:15], a[112:115], a[116:119], v[0:15]
    s_waitcnt vmcnt(7)
    buffer_load_dwordx4 v111, s[52:55], s80 offen offset:3072 lds
    s_add_u32 s84, s93, s90
    s_add_u32 s90, s5, s92
    s_waitcnt lgkmcnt(4)
    v_mfma_f32_32x32x16_bf16 v[16:31], a[112:115], a[120:123], v[16:31]
    ds_read_b64_tr_b16 a[76:77], v120 offset:11264
    ds_read_b64_tr_b16 a[78:79], v120 offset:11520
    ds_read_b128 a[80:83], v107 offset:16384
    ds_read_b128 a[84:87], v107 offset:20480
    s_mul_i32 s88, s4, 42
    s_add_u32 s88, s88, s92
    s_waitcnt lgkmcnt(5)
    v_mfma_f32_32x32x16_bf16 v[0:15], a[64:67], a[68:71], v[0:15]
    s_waitcnt vmcnt(7)
    s_add_u32 m0, s76, 0x1400
    s_add_u32 s80, s80, 229376
    buffer_load_dwordx4 v108, s[52:55], s80 offen lds
    s_add_u32 s90, s90, 1
    s_sub_u32 s91, s90, 7
    s_cselect_b32 s90, s90, s91
    s_waitcnt lgkmcnt(4)
    v_mfma_f32_32x32x16_bf16 v[16:31], a[64:67], a[72:75], v[16:31]
    ds_read_b64_tr_b16 a[88:89], v120 offset:12288
    ds_read_b64_tr_b16 a[90:91], v120 offset:12544
    ds_read_b128 a[92:95], v104 offset:24576
    ds_read_b128 a[96:99], v104 offset:28672
    s_lshl_b32 s91, s90, 7
    s_add_u32 s81, s93, s91
    s_waitcnt lgkmcnt(5)
    v_mfma_f32_32x32x16_bf16 v[0:15], a[76:79], a[80:83], v[0:15]
    s_waitcnt vmcnt(7)
    buffer_load_dwordx4 v109, s[52:55], s80 offen offset:1024 lds
    s_mul_i32 s91, s90, 6
    s_add_u32 s91, s91, s88
    s_waitcnt lgkmcnt(4)
    v_mfma_f32_32x32x16_bf16 v[16:31], a[76:79], a[84:87], v[16:31]
    ds_read_b64_tr_b16 a[100:101], v120 offset:13312
    ds_read_b64_tr_b16 a[102:103], v120 offset:13568
    ds_read_b128 a[104:107], v105 offset:24576
    ds_read_b128 a[108:111], v105 offset:28672
    s_lshl_b32 s91, s91, 13
    s_add_u32 s85, s91, 0x400000
    s_waitcnt lgkmcnt(5)
    v_mfma_f32_32x32x16_bf16 v[0:15], a[88:91], a[92:95], v[0:15]
    s_waitcnt vmcnt(7)
    buffer_load_dwordx4 v110, s[52:55], s80 offen offset:2048 lds
    s_add_u32 s90, s90, 2
    s_sub_u32 s91, s90, 7
    s_cselect_b32 s90, s90, s91
    s_waitcnt lgkmcnt(4)
    v_mfma_f32_32x32x16_bf16 v[16:31], a[88:91], a[96:99], v[16:31]
    ds_read_b64_tr_b16 a[112:113], v120 offset:14336
    ds_read_b64_tr_b16 a[114:115], v120 offset:14592
    ds_read_b128 a[116:119], v106 offset:24576
    ds_read_b128 a[120:123], v106 offset:28672
    s_lshl_b32 s91, s90, 7
    s_add_u32 s82, s93, s91
    s_waitcnt lgkmcnt(5)
    v_mfma_f32_32x32x16_bf16 v[0:15], a[100:103], a[104:107], v[0:15]
    s_waitcnt vmcnt(7)
    buffer_load_dwordx4 v111, s[52:55], s80 offen offset:3072 lds
    s_mov_b32 s10, s91
    s_add_u32 s90, s90, 2
    s_waitcnt lgkmcnt(4)
    v_mfma_f32_32x32x16_bf16 v[16:31], a[100:103], a[108:111], v[16:31]
    ds_read_b64_tr_b16 a[64:65], v120 offset:0
    ds_read_b64_tr_b16 a[66:67], v120 offset:256
    ds_read_b128 a[68:71], v107 offset:24576
    ds_read_b128 a[72:75], v107 offset:28672
    s_sub_u32 s91, s90, 7
    s_cselect_b32 s90, s90, s91
    s_lshl_b32 s91, s90, 7
    s_waitcnt lgkmcnt(5)
    v_mfma_f32_32x32x16_bf16 v[0:15], a[112:115], a[116:119], v[0:15]
    s_waitcnt vmcnt(7)
    s_add_u32 m0, s76, 0x2400
    s_add_u32 s80, s80, 229376
    buffer_load_dwordx4 v108, s[52:55], s80 offen lds
    s_add_u32 s83, s93, s91
    s_sub_u32 s9, s7, s5
    s_waitcnt lgkmcnt(4)
    v_mfma_f32_32x32x16_bf16 v[16:31], a[112:115], a[120:123], v[16:31]
    ds_read_b64_tr_b16 a[76:77], v120 offset:1024
    ds_read_b64_tr_b16 a[78:79], v120 offset:1280
    ds_read_b128 a[80:83], v104 offset:32768
    ds_read_b128 a[84:87], v104 offset:36864
    s_lshl_b32 s9, s9, 7
    s_add_u32 s9, s9, s91
    s_waitcnt lgkmcnt(5)
    v_mfma_f32_32x32x16_bf16 v[0:15], a[64:67], a[68:71], v[0:15]
    s_waitcnt vmcnt(7)
    buffer_load_dwordx4 v109, s[52:55], s80 offen offset:1024 lds
    s_mul_i32 s91, s90, 6
    s_add_u32 s91, s91, s88
    s_waitcnt lgkmcnt(4)
    v_mfma_f32_32x32x16_bf16 v[16:31], a[64:67], a[72:75], v[16:31]
    ds_read_b64_tr_b16 a[88:89], v120 offset:2048
    ds_read_b64_tr_b16 a[90:91], v120 offset:2304
    ds_read_b128 a[92:95], v105 offset:32768
    ds_read_b128 a[96:99], v105 offset:36864
    s_lshl_b32 s91, s91, 13
    s_add_u32 s87, s91, 0x400000
    s_waitcnt lgkmcnt(5)
    v_mfma_f32_32x32x16_bf16 v[0:15], a[76:79], a[80:83], v[0:15]
    s_waitcnt vmcnt(7)
    buffer_load_dwordx4 v110, s[52:55], s80 offen offset:2048 lds
    s_mov_b32 s91, s10
    s_and_b32 s90, s11, 1
    s_waitcnt lgkmcnt(4)
    v_mfma_f32_32x32x16_bf16 v[16:31], a[76:79], a[84:87], v[16:31]
    ds_read_b64_tr_b16 a[100:101], v120 offset:3072
    ds_read_b64_tr_b16 a[102:103], v120 offset:3328
    ds_read_b128 a[104:107], v106 offset:32768
    ds_read_b128 a[108:111], v106 offset:36864
    s_lshl_b32 s93, s4, 5
    s_add_u32 s90, s90, s93
    s_waitcnt lgkmcnt(5)
    v_mfma_f32_32x32x16_bf16 v[0:15], a[88:91], a[92:95], v[0:15]
    s_waitcnt vmcnt(7)
    buffer_load_dwordx4 v111, s[52:55], s80 offen offset:3072 lds
    s_mul_i32 s90, s90, 1792
    s_add_u32 s86, s90, s91
    s_waitcnt lgkmcnt(4)
    v_mfma_f32_32x32x16_bf16 v[16:31], a[88:91], a[96:99], v[16:31]
    ds_read_b64_tr_b16 a[112:113], v120 offset:4096
    ds_read_b64_tr_b16 a[114:115], v120 offset:4352
    ds_read_b128 a[116:119], v107 offset:32768
    ds_read_b128 a[120:123], v107 offset:36864
    s_add_u32 s90, s42, 0x1100000
    s_addc_u32 s91, s43, 0
    s_cmp_eq_u32 s92, 0
    s_cselect_b32 s60, s38, s90
    s_cselect_b32 s61, s39, s91
    s_waitcnt lgkmcnt(5)
    v_mfma_f32_32x32x16_bf16 v[0:15], a[100:103], a[104:107], v[0:15]
    s_waitcnt vmcnt(7)
    s_add_u32 m0, s76, 0x3400
    s_sub_u32 s80, s80, 1376000
    buffer_load_dwordx4 v108, s[52:55], s80 offen lds
    s_and_b32 s61, s61, 0xffff
    s_mov_b32 s62, 1835008
    s_waitcnt lgkmcnt(4)
    v_mfma_f32_32x32x16_bf16 v[16:31], a[100:103], a[108:111], v[16:31]
    ds_read_b64_tr_b16 a[64:65], v120 offset:5120
    ds_read_b64_tr_b16 a[66:67], v120 offset:5376
    ds_read_b128 a[68:71], v104 offset:40960
    ds_read_b128 a[72:75], v104 offset:45056
    s_mov_b32 s89, 0xfffefffe
    s_getreg_b32 s95, hwreg(HW_REG_XCC_ID, 0, 4)
    s_waitcnt lgkmcnt(5)
    v_mfma_f32_32x32x16_bf16 v[0:15], a[112:115], a[116:119], v[0:15]
    s_waitcnt vmcnt(7)
    buffer_load_dwordx4 v109, s[52:55], s80 offen offset:1024 lds
    s_lshl_b32 s94, s3, 12
    s_add_u32 s94, s94, 0x1000000
    s_waitcnt lgkmcnt(4)
    v_mfma_f32_32x32x16_bf16 v[16:31], a[112:115], a[120:123], v[16:31]
    ds_read_b64_tr_b16 a[76:77], v120 offset:6144
    ds_read_b64_tr_b16 a[78:79], v120 offset:6400
    ds_read_b128 a[80:83], v105 offset:40960
    ds_read_b128 a[84:87], v105 offset:45056
    s_lshl_b32 s95, s95, 2
    s_add_u32 s9, s9, s94
    s_waitcnt lgkmcnt(5)
    v_mfma_f32_32x32x16_bf16 v[0:15], a[64:67], a[68:71], v[0:15]
    s_waitcnt vmcnt(7)
    s_add_u32 m0, s76, 0xfffff800
    s_nop 0
    buffer_load_dwordx4 v110, s[52:55], s80 offen offset:2048 lds
    s_cmp_eq_u32 s3, 7
    s_cselect_b32 s90, 4, 0
    v_and_b32 v94, 31, v127
    s_waitcnt lgkmcnt(4)
    v_mfma_f32_32x32x16_bf16 v[16:31], a[64:67], a[72:75], v[16:31]
    ds_read_b64_tr_b16 a[88:89], v120 offset:7168
    ds_read_b64_tr_b16 a[90:91], v120 offset:7424
    ds_read_b128 a[92:95], v106 offset:40960
    ds_read_b128 a[96:99], v106 offset:45056
    v_max_u32 v94, s90, v94
    v_lshlrev_b32 v94, 7, v94
    s_waitcnt lgkmcnt(5)
    v_mfma_f32_32x32x16_bf16 v[0:15], a[76:79], a[80:83], v[0:15]
    s_waitcnt vmcnt(7)
    buffer_load_dwordx4 v111, s[52:55], s80 offen offset:3072 lds
    s_waitcnt lgkmcnt(4)
    v_mfma_f32_32x32x16_bf16 v[16:31], a[76:79], a[84:87], v[16:31]
    ds_read_b64_tr_b16 a[100:101], v120 offset:8192
    ds_read_b64_tr_b16 a[102:103], v120 offset:8448
    ds_read_b128 a[104:107], v107 offset:40960
    ds_read_b128 a[108:111], v107 offset:45056
    s_waitcnt lgkmcnt(5)
    v_mfma_f32_32x32x16_bf16 v[0:15], a[88:91], a[92:95], v[0:15]
    s_waitcnt vmcnt(7)
    s_add_u32 m0, s76, 0x800
    s_add_u32 s80, s80, 229376
    buffer_load_dwordx4 v108, s[52:55], s80 offen lds
    s_waitcnt lgkmcnt(4)
    v_mfma_f32_32x32x16_bf16 v[16:31], a[88:91], a[96:99], v[16:31]
    ds_read_b64_tr_b16 a[112:113], v120 offset:9216
    ds_read_b64_tr_b16 a[114:115], v120 offset:9472
    ds_read_b128 a[116:119], v104 offset:49152
    ds_read_b128 a[120:123], v104 offset:53248
    s_waitcnt lgkmcnt(5)
    v_mfma_f32_32x32x16_bf16 v[0:15], a[100:103], a[104:107], v[0:15]
    s_waitcnt vmcnt(7)
    buffer_load_dwordx4 v109, s[52:55], s80 offen offset:1024 lds
    s_waitcnt lgkmcnt(4)
    v_mfma_f32_32x32x16_bf16 v[16:31], a[100:103], a[108:111], v[16:31]
    ds_read_b64_tr_b16 a[64:65], v120 offset:10240
    ds_read_b64_tr_b16 a[66:67], v120 offset:10496
    ds_read_b128 a[68:71], v105 offset:49152
    ds_read_b128 a[72:75], v105 offset:53248
    s_waitcnt lgkmcnt(5)
    v_mfma_f32_32x32x16_bf16 v[0:15], a[112:115], a[116:119], v[0:15]
    s_waitcnt vmcnt(7)
    buffer_load_dwordx4 v110, s[52:55], s80 offen offset:2048 lds
    s_waitcnt lgkmcnt(4)
    v_mfma_f32_32x32x16_bf16 v[16:31], a[112:115], a[120:123], v[16:31]
    ds_read_b64_tr_b16 a[76:77], v120 offset:11264
    ds_read_b64_tr_b16 a[78:79], v120 offset:11520
    ds_read_b128 a[80:83], v106 offset:49152
    ds_read_b128 a[84:87], v106 offset:53248
    s_waitcnt lgkmcnt(5)
    v_mfma_f32_32x32x16_bf16 v[0:15], a[64:67], a[68:71], v[0:15]
    s_waitcnt vmcnt(7)
    buffer_load_dwordx4 v111, s[52:55], s80 offen offset:3072 lds
    s_waitcnt lgkmcnt(4)
    v_mfma_f32_32x32x16_bf16 v[16:31], a[64:67], a[72:75], v[16:31]
    ds_read_b64_tr_b16 a[88:89], v120 offset:12288
    ds_read_b64_tr_b16 a[90:91], v120 offset:12544
    ds_read_b128 a[92:95], v107 offset:49152
    ds_read_b128 a[96:99], v107 offset:53248
    s_waitcnt lgkmcnt(5)
    v_mfma_f32_32x32x16_bf16 v[0:15], a[76:79], a[80:83], v[0:15]
    s_waitcnt vmcnt(7)
    s_add_u32 m0, s76, 0x1800
    s_add_u32 s80, s80, 229376
    buffer_load_dwordx4 v108, s[52:55], s80 offen lds
    s_waitcnt lgkmcnt(4)
    v_mfma_f32_32x32x16_bf16 v[16:31], a[76:79], a[84:87], v[16:31]
    ds_read_b64_tr_b16 a[100:101], v120 offset:13312
    ds_read_b64_tr_b16 a[102:103], v120 offset:13568
    ds_read_b128 a[104:107], v104 offset:0
    ds_read_b128 a[108:111], v104 offset:4096
    s_waitcnt lgkmcnt(5)
    v_mfma_f32_32x32x16_bf16 v[0:15], a[88:91], a[92:95], v[0:15]
    s_waitcnt vmcnt(7)
    buffer_load_dwordx4 v109, s[52:55], s80 offen offset:1024 lds
    s_waitcnt lgkmcnt(4)
    v_mfma_f32_32x32x16_bf16 v[16:31], a[88:91], a[96:99], v[16:31]
    ds_read_b64_tr_b16 a[112:113], v120 offset:14336
    ds_read_b64_tr_b16 a[114:115], v120 offset:14592
    ds_read_b128 a[116:119], v105 offset:0
    ds_read_b128 a[120:123], v105 offset:4096
    s_waitcnt lgkmcnt(5)
    v_mfma_f32_32x32x16_bf16 v[32:47], a[100:103], a[104:107], v[48:63]
    s_waitcnt vmcnt(7)
    buffer_load_dwordx4 v110, s[52:55], s80 offen offset:2048 lds
    s_waitcnt lgkmcnt(4)
    v_mfma_f32_32x32x16_bf16 v[48:63], a[100:103], a[108:111], v[48:63]
    ds_read_b64_tr_b16 a[64:65], v120 offset:0
    ds_read_b64_tr_b16 a[66:67], v120 offset:256
    ds_read_b128 a[68:71], v106 offset:0
    ds_read_b128 a[72:75], v106 offset:4096
    s_waitcnt lgkmcnt(5)
    v_mfma_f32_32x32x16_bf16 v[32:47], a[112:115], a[116:119], v[32:47]
    s_waitcnt vmcnt(7)
    buffer_load_dwordx4 v111, s[52:55], s80 offen offset:3072 lds
    v_fma_f32 v96, v0, s74, -0.5
    v_fma_f32 v97, v1, s74, -0.5
    v_fma_f32 v98, v2, s74, -0.5
    v_fma_f32 v99, v3, s74, -0.5
    v_exp_f32 v96, v96
    s_waitcnt lgkmcnt(4)
    v_mfma_f32_32x32x16_bf16 v[48:63], a[112:115], a[120:123], v[48:63]
    ds_read_b64_tr_b16 a[76:77], v120 offset:1024
    ds_read_b64_tr_b16 a[78:79], v120 offset:1280
    ds_read_b128 a[80:83], v107 offset:0
    ds_read_b128 a[84:87], v107 offset:4096
    v_exp_f32 v97, v97
    v_exp_f32 v98, v98
    v_exp_f32 v99, v99
    v_add_f32 v96, 0x3f3504f3, v96
    v_add_f32 v97, 0x3f3504f3, v97
    v_add_f32 v98, 0x3f3504f3, v98
    s_waitcnt lgkmcnt(5)
    v_mfma_f32_32x32x16_bf16 v[32:47], a[64:67], a[68:71], v[32:47]
    s_waitcnt vmcnt(7)
    s_add_u32 m0, s76, 0x2800
    s_add_u32 s80, s80, 229376
    buffer_load_dwordx4 v108, s[52:55], s80 offen lds
    v_add_f32 v99, 0x3f3504f3, v99
    v_fma_f32 v96, v96, v96, 0.5
    v_fma_f32 v97, v97, v97, 0.5
    v_fma_f32 v98, v98, v98, 0.5
    v_fma_f32 v99, v99, v99, 0.5
    s_waitcnt lgkmcnt(4)
    v_mfma_f32_32x32x16_bf16 v[48:63], a[64:67], a[72:75], v[48:63]
    ds_read_b64_tr_b16 a[88:89], v120 offset:2048
    ds_read_b64_tr_b16 a[90:91], v120 offset:2304
    ds_read_b128 a[92:95], v104 offset:8192
    ds_read_b128 a[96:99], v104 offset:12288
    v_rcp_f32 v96, v96
    v_rcp_f32 v97, v97
    v_rcp_f32 v98, v98
    v_rcp_f32 v99, v99
    v_fma_f32 v0, -v96, v0, v0
    v_fma_f32 v1, -v97, v1, v1
    s_waitcnt lgkmcnt(5)
    v_mfma_f32_32x32x16_bf16 v[32:47], a[76:79], a[80:83], v[32:47]
    s_waitcnt vmcnt(7)
    s_add_u32 m0, s76, 0xfffffc00
    v_fma_f32 v2, -v98, v2, v2
    buffer_load_dwordx4 v109, s[52:55], s80 offen offset:1024 lds
    v_fma_f32 v3, -v99, v3, v3
    v_cvt_pk_bf16_f32 v0, v0, v1
    v_cvt_pk_bf16_f32 v1, v2, v3
    v_fma_f32 v100, v4, s74, -0.5
    v_fma_f32 v101, v5, s74, -0.5
    s_waitcnt lgkmcnt(4)
    v_mfma_f32_32x32x16_bf16 v[48:63], a[76:79], a[84:87], v[48:63]
    ds_read_b64_tr_b16 a[100:101], v120 offset:3072
    ds_read_b64_tr_b16 a[102:103], v120 offset:3328
    ds_read_b128 a[104:107], v105 offset:8192
    ds_read_b128 a[108:111], v105 offset:12288
    v_fma_f32 v102, v6, s74, -0.5
    v_fma_f32 v103, v7, s74, -0.5
    v_exp_f32 v100, v100
    v_exp_f32 v101, v101
    v_exp_f32 v102, v102
    v_exp_f32 v103, v103
    s_waitcnt lgkmcnt(5)
    v_mfma_f32_32x32x16_bf16 v[32:47], a[88:91], a[92:95], v[32:47]
    s_waitcnt vmcnt(7)
    buffer_load_dwordx4 v110, s[52:55], s80 offen offset:2048 lds
    v_add_f32 v100, 0x3f3504f3, v100
    v_add_f32 v101, 0x3f3504f3, v101
    v_add_f32 v102, 0x3f3504f3, v102
    v_add_f32 v103, 0x3f3504f3, v103
    v_fma_f32 v100, v100, v100, 0.5
    s_waitcnt lgkmcnt(4)
    v_mfma_f32_32x32x16_bf16 v[48:63], a[88:91], a[96:99], v[48:63]
    ds_read_b64_tr_b16 a[112:113], v120 offset:4096
    ds_read_b64_tr_b16 a[114:115], v120 offset:4352
    ds_read_b128 a[116:119], v106 offset:8192
    ds_read_b128 a[120:123], v106 offset:12288
    v_fma_f32 v101, v101, v101, 0.5
    v_fma_f32 v102, v102, v102, 0.5
    v_fma_f32 v103, v103, v103, 0.5
    v_rcp_f32 v100, v100
    v_rcp_f32 v101, v101
    v_rcp_f32 v102, v102
    s_waitcnt lgkmcnt(5)
    v_mfma_f32_32x32x16_bf16 v[32:47], a[100:103], a[104:107], v[32:47]
    s_waitcnt vmcnt(7)
    buffer_load_dwordx4 v111, s[52:55], s80 offen offset:3072 lds
    v_rcp_f32 v103, v103
    v_fma_f32 v4, -v100, v4, v4
    v_fma_f32 v5, -v101, v5, v5
    v_fma_f32 v6, -v102, v6, v6
    v_fma_f32 v7, -v103, v7, v7
    s_waitcnt lgkmcnt(4)
    v_mfma_f32_32x32x16_bf16 v[48:63], a[100:103], a[108:111], v[48:63]
    ds_read_b64_tr_b16 a[64:65], v120 offset:5120
    ds_read_b64_tr_b16 a[66:67], v120 offset:5376
    ds_read_b128 a[68:71], v107 offset:8192
    ds_read_b128 a[72:75], v107 offset:12288
    v_cvt_pk_bf16_f32 v2, v4, v5
    v_cvt_pk_bf16_f32 v3, v6, v7
    v_fma_f32 v96, v8, s74, -0.5
    v_fma_f32 v97, v9, s74, -0.5
    v_fma_f32 v98, v10, s74, -0.5
    v_fma_f32 v99, v11, s74, -0.5
    s_waitcnt lgkmcnt(5)
    v_mfma_f32_32x32x16_bf16 v[32:47], a[112:115], a[116:119], v[32:47]
    s_waitcnt vmcnt(7)
    s_add_u32 m0, s76, 0xc00
    s_add_u32 s80, s80, 229376
    buffer_load_dwordx4 v108, s[52:55], s80 offen lds
    v_exp_f32 v96, v96
    v_exp_f32 v97, v97
    v_exp_f32 v98, v98
    v_exp_f32 v99, v99
    v_add_f32 v96, 0x3f3504f3, v96
    s_waitcnt lgkmcnt(4)
    v_mfma_f32_32x32x16_bf16 v[48:63], a[112:115], a[120:123], v[48:63]
    ds_read_b64_tr_b16 a[76:77], v120 offset:6144
    ds_read_b64_tr_b16 a[78:79], v120 offset:6400
    ds_read_b128 a[80:83], v104 offset:16384
    ds_read_b128 a[84:87], v104 offset:20480
    v_add_f32 v97, 0x3f3504f3, v97
    v_add_f32 v98, 0x3f3504f3, v98
    v_add_f32 v99, 0x3f3504f3, v99
    v_fma_f32 v96, v96, v96, 0.5
    v_fma_f32 v97, v97, v97, 0.5
    v_fma_f32 v98, v98, v98, 0.5
    s_waitcnt lgkmcnt(5)
    v_mfma_f32_32x32x16_bf16 v[32:47], a[64:67], a[68:71], v[32:47]
    s_waitcnt vmcnt(7)
    buffer_load_dwordx4 v109, s[52:55], s80 offen offset:1024 lds
    v_fma_f32 v99, v99, v99, 0.5
    v_rcp_f32 v96, v96
    v_rcp_f32 v97, v97
    v_rcp_f32 v98, v98
    v_rcp_f32 v99, v99
    s_waitcnt lgkmcnt(4)
    v_mfma_f32_32x32x16_bf16 v[48:63], a[64:67], a[72:75], v[48:63]
    ds_read_b64_tr_b16 a[88:89], v120 offset:7168
    ds_read_b64_tr_b16 a[90:91], v120 offset:7424
    ds_read_b128 a[92:95], v105 offset:16384
    ds_read_b128 a[96:99], v105 offset:20480
    v_fma_f32 v8, -v96, v8, v8
    v_fma_f32 v9, -v97, v9, v9
    v_fma_f32 v10, -v98, v10, v10
    v_fma_f32 v11, -v99, v11, v11
    v_cvt_pk_bf16_f32 v4, v8, v9
    v_cvt_pk_bf16_f32 v5, v10, v11
    s_waitcnt lgkmcnt(5)
    v_mfma_f32_32x32x16_bf16 v[32:47], a[76:79], a[80:83], v[32:47]
    s_waitcnt vmcnt(7)
    buffer_load_dwordx4 v110, s[52:55], s80 offen offset:2048 lds
    v_fma_f32 v100, v12, s74, -0.5
    v_fma_f32 v101, v13, s74, -0.5
    v_fma_f32 v102, v14, s74, -0.5
    v_fma_f32 v103, v15, s74, -0.5
    v_exp_f32 v100, v100
    s_waitcnt lgkmcnt(4)
    v_mfma_f32_32x32x16_bf16 v[48:63], a[76:79], a[84:87], v[48:63]
    ds_read_b64_tr_b16 a[100:101], v120 offset:8192
    ds_read_b64_tr_b16 a[102:103], v120 offset:8448
    ds_read_b128 a[104:107], v106 offset:16384
    ds_read_b128 a[108:111], v106 offset:20480
    v_exp_f32 v101, v101
    v_exp_f32 v102, v102
    v_exp_f32 v103, v103
    v_add_f32 v100, 0x3f3504f3, v100
    v_add_f32 v101, 0x3f3504f3, v101
    v_add_f32 v102, 0x3f3504f3, v102
    s_waitcnt lgkmcnt(5)
    v_mfma_f32_32x32x16_bf16 v[32:47], a[88:91], a[92:95], v[32:47]
    s_waitcnt vmcnt(7)
    buffer_load_dwordx4 v111, s[52:55], s80 offen offset:3072 lds
    v_add_f32 v103, 0x3f3504f3, v103
    v_fma_f32 v100, v100, v100, 0.5
    v_fma_f32 v101, v101, v101, 0.5
    v_fma_f32 v102, v102, v102, 0.5
    v_fma_f32 v103, v103, v103, 0.5
    s_waitcnt lgkmcnt(4)
    v_mfma_f32_32x32x16_bf16 v[48:63], a[88:91], a[96:99], v[48:63]
    ds_read_b64_tr_b16 a[112:113], v120 offset:9216
    ds_read_b64_tr_b16 a[114:115], v120 offset:9472
    ds_read_b128 a[116:119], v107 offset:16384
    ds_read_b128 a[120:123], v107 offset:20480
    v_rcp_f32 v100, v100
    v_rcp_f32 v101, v101
    v_rcp_f32 v102, v102
    v_rcp_f32 v103, v103
    v_fma_f32 v12, -v100, v12, v12
    v_fma_f32 v13, -v101, v13, v13
    s_waitcnt lgkmcnt(5)
    v_mfma_f32_32x32x16_bf16 v[32:47], a[100:103], a[104:107], v[32:47]
    s_waitcnt vmcnt(7)
    s_add_u32 m0, s76, 0x1c00
    s_add_u32 s80, s80, 229376
    buffer_load_dwordx4 v108, s[52:55], s80 offen lds
    v_fma_f32 v14, -v102, v14, v14
    v_fma_f32 v15, -v103, v15, v15
    v_cvt_pk_bf16_f32 v6, v12, v13
    v_cvt_pk_bf16_f32 v7, v14, v15
    ds_write_b128 v90, v[0:3] offset:11264
    ds_write_b128 v90, v[4:7] offset:12288
    s_waitcnt lgkmcnt(6)
    v_mfma_f32_32x32x16_bf16 v[48:63], a[100:103], a[108:111], v[48:63]
    ds_read_b64_tr_b16 a[64:65], v120 offset:10240
    ds_read_b64_tr_b16 a[66:67], v120 offset:10496
    ds_read_b128 a[68:71], v104 offset:24576
    ds_read_b128 a[72:75], v104 offset:28672
    v_fma_f32 v96, v16, s74, -0.5
    v_fma_f32 v97, v17, s74, -0.5
    v_fma_f32 v98, v18, s74, -0.5
    v_fma_f32 v99, v19, s74, -0.5
    v_exp_f32 v96, v96
    v_exp_f32 v97, v97
    s_waitcnt lgkmcnt(7)
    v_mfma_f32_32x32x16_bf16 v[32:47], a[112:115], a[116:119], v[32:47]
    s_waitcnt vmcnt(7)
    buffer_load_dwordx4 v109, s[52:55], s80 offen offset:1024 lds
    v_exp_f32 v98, v98
    v_exp_f32 v99, v99
    v_add_f32 v96, 0x3f3504f3, v96
    v_add_f32 v97, 0x3f3504f3, v97
    v_add_f32 v98, 0x3f3504f3, v98
    s_waitcnt lgkmcnt(6)
    v_mfma_f32_32x32x16_bf16 v[48:63], a[112:115], a[120:123], v[48:63]
    ds_read_b64_tr_b16 a[76:77], v120 offset:0
    ds_read_b64_tr_b16 a[78:79], v120 offset:256
    ds_read_b128 a[80:83], v105 offset:24576
    ds_read_b128 a[84:87], v105 offset:28672
    v_add_f32 v99, 0x3f3504f3, v99
    v_fma_f32 v96, v96, v96, 0.5
    v_fma_f32 v97, v97, v97, 0.5
    v_fma_f32 v98, v98, v98, 0.5
    v_fma_f32 v99, v99, v99, 0.5
    v_rcp_f32 v96, v96
    s_waitcnt lgkmcnt(5)
    v_mfma_f32_32x32x16_bf16 v[32:47], a[64:67], a[68:71], v[32:47]
    s_waitcnt vmcnt(7)
    buffer_load_dwordx4 v110, s[52:55], s80 offen offset:2048 lds
    v_rcp_f32 v97, v97
    v_rcp_f32 v98, v98
    v_rcp_f32 v99, v99
    v_fma_f32 v16, -v96, v16, v16
    v_fma_f32 v17, -v97, v17, v17
    s_waitcnt lgkmcnt(4)
    v_mfma_f32_32x32x16_bf16 v[48:63], a[64:67], a[72:75], v[48:63]
    ds_read_b64_tr_b16 a[88:89], v120 offset:1024
    ds_read_b64_tr_b16 a[90:91], v120 offset:1280
    ds_read_b128 a[92:95], v106 offset:24576
    ds_read_b128 a[96:99], v106 offset:28672
    v_fma_f32 v18, -v98, v18, v18
    v_fma_f32 v19, -v99, v19, v19
    v_cvt_pk_bf16_f32 v16, v16, v17
    v_cvt_pk_bf16_f32 v17, v18, v19
    v_fma_f32 v100, v20, s74, -0.5
    v_fma_f32 v101, v21, s74, -0.5
    s_waitcnt lgkmcnt(5)
    v_mfma_f32_32x32x16_bf16 v[32:47], a[76:79], a[80:83], v[32:47]
    s_waitcnt vmcnt(7)
    buffer_load_dwordx4 v111, s[52:55], s80 offen offset:3072 lds
    v_fma_f32 v102, v22, s74, -0.5
    v_fma_f32 v103, v23, s74, -0.5
    v_exp_f32 v100, v100
    v_exp_f32 v101, v101
    v_exp_f32 v102, v102
    s_waitcnt lgkmcnt(4)
    v_mfma_f32_32x32x16_bf16 v[48:63], a[76:79], a[84:87], v[48:63]
    ds_read_b64_tr_b16 a[100:101], v120 offset:2048
    ds_read_b64_tr_b16 a[102:103], v120 offset:2304
    ds_read_b128 a[104:107], v107 offset:24576
    ds_read_b128 a[108:111], v107 offset:28672
    v_exp_f32 v103, v103
    v_add_f32 v100, 0x3f3504f3, v100
    v_add_f32 v101, 0x3f3504f3, v101
    v_add_f32 v102, 0x3f3504f3, v102
    v_add_f32 v103, 0x3f3504f3, v103
    v_fma_f32 v100, v100, v100, 0.5
    s_waitcnt lgkmcnt(5)
    v_mfma_f32_32x32x16_bf16 v[32:47], a[88:91], a[92:95], v[32:47]
    s_waitcnt vmcnt(7)
    s_add_u32 m0, s76, 0x0
    s_add_u32 s80, s80, 229376
    buffer_load_dwordx4 v108, s[52:55], s80 offen lds
    v_fma_f32 v101, v101, v101, 0.5
    v_fma_f32 v102, v102, v102, 0.5
    v_fma_f32 v103, v103, v103, 0.5
    v_rcp_f32 v100, v100
    v_rcp_f32 v101, v101
    s_waitcnt lgkmcnt(4)
    v_mfma_f32_32x32x16_bf16 v[48:63], a[88:91], a[96:99], v[48:63]
    ds_read_b64_tr_b16 a[112:113], v120 offset:3072
    ds_read_b64_tr_b16 a[114:115], v120 offset:3328
    ds_read_b128 a[116:119], v104 offset:32768
    ds_read_b128 a[120:123], v104 offset:36864
    v_rcp_f32 v102, v102
    v_rcp_f32 v103, v103
    v_fma_f32 v20, -v100, v20, v20
    v_fma_f32 v21, -v101, v21, v21
    v_fma_f32 v22, -v102, v22, v22
    v_fma_f32 v23, -v103, v23, v23
    s_waitcnt lgkmcnt(5)
    v_mfma_f32_32x32x16_bf16 v[32:47], a[100:103], a[104:107], v[32:47]
    s_waitcnt vmcnt(7)
    buffer_load_dwordx4 v109, s[52:55], s80 offen offset:1024 lds
    v_cvt_pk_bf16_f32 v18, v20, v21
    v_cvt_pk_bf16_f32 v19, v22, v23
    v_fma_f32 v96, v24, s74, -0.5
    v_fma_f32 v97, v25, s74, -0.5
    v_fma_f32 v98, v26, s74, -0.5
    s_waitcnt lgkmcnt(4)
    v_mfma_f32_32x32x16_bf16 v[48:63], a[100:103], a[108:111], v[48:63]
    ds_read_b64_tr_b16 a[64:65], v120 offset:4096
    ds_read_b64_tr_b16 a[66:67], v120 offset:4352
    ds_read_b128 a[68:71], v105 offset:32768
    ds_read_b128 a[72:75], v105 offset:36864
    v_fma_f32 v99, v27, s74, -0.5
    v_exp_f32 v96, v96
    v_exp_f32 v97, v97
    v_exp_f32 v98, v98
    v_exp_f32 v99, v99
    v_add_f32 v96, 0x3f3504f3, v96
    s_waitcnt lgkmcnt(5)
    v_mfma_f32_32x32x16_bf16 v[32:47], a[112:115], a[116:119], v[32:47]
    s_waitcnt vmcnt(7)
    buffer_load_dwordx4 v110, s[52:55], s80 offen offset:2048 lds
    v_add_f32 v97, 0x3f3504f3, v97
    v_add_f32 v98, 0x3f3504f3, v98
    v_add_f32 v99, 0x3f3504f3, v99
    v_fma_f32 v96, v96, v96, 0.5
    v_fma_f32 v97, v97, v97, 0.5
    s_waitcnt lgkmcnt(4)
    v_mfma_f32_32x32x16_bf16 v[48:63], a[112:115], a[120:123], v[48:63]
    ds_read_b64_tr_b16 a[76:77], v120 offset:5120
    ds_read_b64_tr_b16 a[78:79], v120 offset:5376
    ds_read_b128 a[80:83], v106 offset:32768
    ds_read_b128 a[84:87], v106 offset:36864
    v_fma_f32 v98, v98, v98, 0.5
    v_fma_f32 v99, v99, v99, 0.5
    v_rcp_f32 v96, v96
    v_rcp_f32 v97, v97
    v_rcp_f32 v98, v98
    v_rcp_f32 v99, v99
    s_waitcnt lgkmcnt(5)
    v_mfma_f32_32x32x16_bf16 v[32:47], a[64:67], a[68:71], v[32:47]
    s_waitcnt vmcnt(7)
    buffer_load_dwordx4 v111, s[52:55], s80 offen offset:3072 lds
    v_fma_f32 v24, -v96, v24, v24
    v_fma_f32 v25, -v97, v25, v25
    v_fma_f32 v26, -v98, v26, v26
    v_fma_f32 v27, -v99, v27, v27
    v_cvt_pk_bf16_f32 v20, v24, v25
    s_waitcnt lgkmcnt(4)
    v_mfma_f32_32x32x16_bf16 v[48:63], a[64:67], a[72:75], v[48:63]
    ds_read_b64_tr_b16 a[88:89], v120 offset:6144
    ds_read_b64_tr_b16 a[90:91], v120 offset:6400
    ds_read_b128 a[92:95], v107 offset:32768
    ds_read_b128 a[96:99], v107 offset:36864
    v_cvt_pk_bf16_f32 v21, v26, v27
    v_fma_f32 v100, v28, s74, -0.5
    v_fma_f32 v101, v29, s74, -0.5
    v_fma_f32 v102, v30, s74, -0.5
    v_fma_f32 v103, v31, s74, -0.5
    v_exp_f32 v100, v100
    s_waitcnt lgkmcnt(5)
    v_mfma_f32_32x32x16_bf16 v[32:47], a[76:79], a[80:83], v[32:47]
    s_waitcnt vmcnt(7)
    s_add_u32 m0, s76, 0x1000
    v_exp_f32 v101, v101
    buffer_load_dwordx4 v112, s[56:59], s81 offen lds
    v_exp_f32 v102, v102
    v_exp_f32 v103, v103
    v_add_f32 v100, 0x3f3504f3, v100
    v_add_f32 v101, 0x3f3504f3, v101
    v_add_f32 v102, 0x3f3504f3, v102
    s_waitcnt lgkmcnt(4)
    v_mfma_f32_32x32x16_bf16 v[48:63], a[76:79], a[84:87], v[48:63]
    ds_read_b64_tr_b16 a[100:101], v120 offset:7168
    ds_read_b64_tr_b16 a[102:103], v120 offset:7424
    ds_read_b128 a[104:107], v104 offset:40960
    ds_read_b128 a[108:111], v104 offset:45056
    v_add_f32 v103, 0x3f3504f3, v103
    v_fma_f32 v100, v100, v100, 0.5
    v_fma_f32 v101, v101, v101, 0.5
    v_fma_f32 v102, v102, v102, 0.5
    v_fma_f32 v103, v103, v103, 0.5
    v_rcp_f32 v100, v100
    s_waitcnt lgkmcnt(5)
    v_mfma_f32_32x32x16_bf16 v[32:47], a[88:91], a[92:95], v[32:47]
    s_waitcnt vmcnt(7)
    buffer_load_dwordx4 v113, s[56:59], s81 offen offset:1024 lds
    v_rcp_f32 v101, v101
    v_rcp_f32 v102, v102
    v_rcp_f32 v103, v103
    v_fma_f32 v28, -v100, v28, v28
    v_fma_f32 v29, -v101, v29, v29
    s_waitcnt lgkmcnt(4)
    v_mfma_f32_32x32x16_bf16 v[48:63], a[88:91], a[96:99], v[48:63]
    ds_read_b64_tr_b16 a[112:113], v120 offset:8192
    ds_read_b64_tr_b16 a[114:115], v120 offset:8448
    ds_read_b128 a[116:119], v105 offset:40960
    ds_read_b128 a[120:123], v105 offset:45056
    v_fma_f32 v30, -v102, v30, v30
    v_fma_f32 v31, -v103, v31, v31
    v_cvt_pk_bf16_f32 v22, v28, v29
    v_cvt_pk_bf16_f32 v23, v30, v31
    ds_write_b128 v90, v[16:19] offset:13312
    ds_write_b128 v90, v[20:23] offset:14336
    v_mov_b32 v95, 2
    ds_write_b32 v121, v95 offset:0
    s_waitcnt lgkmcnt(8)
    v_mfma_f32_32x32x16_bf16 v[32:47], a[100:103], a[104:107], v[32:47]
    s_waitcnt vmcnt(7)
    buffer_load_dwordx4 v114, s[56:59], s81 offen offset:2048 lds
    s_waitcnt lgkmcnt(7)
    v_mfma_f32_32x32x16_bf16 v[48:63], a[100:103], a[108:111], v[48:63]
    ds_read_b64_tr_b16 a[64:65], v120 offset:9216
    ds_read_b64_tr_b16 a[66:67], v120 offset:9472
    ds_read_b128 a[68:71], v106 offset:40960
    ds_read_b128 a[72:75], v106 offset:45056
    s_waitcnt lgkmcnt(8)
    v_mfma_f32_32x32x16_bf16 v[32:47], a[112:115], a[116:119], v[32:47]
    s_waitcnt vmcnt(7)
    buffer_load_dwordx4 v115, s[56:59], s81 offen offset:3072 lds
    s_waitcnt lgkmcnt(7)
    v_mfma_f32_32x32x16_bf16 v[48:63], a[112:115], a[120:123], v[48:63]
    ds_read_b64_tr_b16 a[76:77], v120 offset:10240
    ds_read_b64_tr_b16 a[78:79], v120 offset:10496
    ds_read_b128 a[80:83], v107 offset:40960
    ds_read_b128 a[84:87], v107 offset:45056
    ds_read_b32 v123, v122 offset:0
    v_mov_b32 v95, 0
    ds_read_b32 v93, v95 offset:68
    buffer_load_dword v94, v94, s[44:47], s94 offen sc1
    s_waitcnt lgkmcnt(7)
    v_mfma_f32_32x32x16_bf16 v[32:47], a[64:67], a[68:71], v[32:47]
    s_waitcnt vmcnt(8)
    s_add_u32 m0, s76, 0x2000
    s_add_u32 s81, s81, 57344
    buffer_load_dwordx4 v112, s[56:59], s81 offen lds
    s_waitcnt lgkmcnt(1)
    v_cmp_gt_u32 vcc, 2, v123
    s_cbranch_vccz CK_4
    s_mov_b32 s75, 65536
LS_5:
    ds_read_b32 v123, v122 offset:0
    s_sub_u32 s75, s75, 1
    s_cmp_eq_u32 s75, 0
    s_cbranch_scc1 LD_6
    s_waitcnt lgkmcnt(0)
    v_cmp_gt_u32 vcc, 2, v123
    s_cbranch_vccnz LS_5
LD_6:
    s_waitcnt lgkmcnt(0)
CK_4:
    ds_read_b128 a[0:3], v88 offset:11264
    ds_read_b128 a[8:11], v88 offset:13312
    ds_read_b128 a[4:7], v89 offset:11264
    ds_read_b128 a[12:15], v89 offset:13312
    v_mfma_f32_32x32x16_bf16 v[48:63], a[64:67], a[72:75], v[48:63]
    ds_read_b64_tr_b16 a[88:89], v120 offset:0
    ds_read_b64_tr_b16 a[90:91], v120 offset:256
    ds_read_b128 a[92:95], v104 offset:49152
    ds_read_b128 a[96:99], v104 offset:53248
    ds_read_b128 a[16:19], v88 offset:26624
    ds_read_b128 a[24:27], v88 offset:28672
    s_waitcnt vmcnt(8)
    buffer_load_dwordx4 v113, s[56:59], s81 offen offset:1024 lds
    ds_read_b128 a[20:23], v89 offset:26624
    ds_read_b128 a[28:31], v89 offset:28672
    ds_read_b128 a[32:35], v88 offset:41984
    ds_read_b128 a[40:43], v88 offset:44032
    v_mfma_f32_32x32x16_bf16 v[32:47], a[76:79], a[80:83], v[32:47]
    ds_read_b128 a[36:39], v89 offset:41984
    ds_read_b128 a[44:47], v89 offset:44032
    ds_read_b128 a[48:51], v88 offset:57344
    ds_read_b128 a[56:59], v88 offset:59392
    ds_read_b128 a[52:55], v89 offset:57344
    v_mfma_f32_32x32x16_bf16 v[48:63], a[76:79], a[84:87], v[48:63]
    ds_read_b64_tr_b16 a[100:101], v120 offset:1024
    ds_read_b64_tr_b16 a[102:103], v120 offset:1280
    ds_read_b128 a[104:107], v105 offset:49152
    ds_read_b128 a[108:111], v105 offset:53248
    ds_read_b128 a[60:63], v89 offset:59392
    s_waitcnt lgkmcnt(15)
    v_mfma_f32_32x32x16_bf16 v[32:47], a[88:91], a[92:95], v[32:47]
    s_waitcnt vmcnt(8)
    buffer_load_dwordx4 v114, s[56:59], s81 offen offset:2048 lds
    v_mfma_f32_32x32x16_bf16 v[48:63], a[88:91], a[96:99], v[48:63]
    ds_read_b64_tr_b16 a[112:113], v120 offset:2048
    ds_read_b64_tr_b16 a[114:115], v120 offset:2304
    ds_read_b128 a[116:119], v106 offset:49152
    ds_read_b128 a[120:123], v106 offset:53248
    s_waitcnt lgkmcnt(6)
    v_mfma_f32_32x32x16_bf16 v[32:47], a[100:103], a[104:107], v[32:47]
    s_waitcnt vmcnt(8)
    s_add_u32 m0, s76, 0xfffff400
    s_nop 0
    buffer_load_dwordx4 v115, s[56:59], s81 offen offset:3072 lds
    s_waitcnt lgkmcnt(5)
    v_mfma_f32_32x32x16_bf16 v[48:63], a[100:103], a[108:111], v[48:63]
    ds_read_b64_tr_b16 a[64:65], v120 offset:3072
    ds_read_b64_tr_b16 a[66:67], v120 offset:3328
    ds_read_b128 a[68:71], v107 offset:49152
    ds_read_b128 a[72:75], v107 offset:53248
    s_waitcnt lgkmcnt(5)
    v_mfma_f32_32x32x16_bf16 v[32:47], a[112:115], a[116:119], v[32:47]
    s_waitcnt vmcnt(8)
    s_add_u32 m0, s76, 0x400
    s_add_u32 s81, s81, 57344
    buffer_load_dwordx4 v112, s[56:59], s81 offen lds
    s_waitcnt lgkmcnt(4)
    v_mfma_f32_32x32x16_bf16 v[48:63], a[112:115], a[120:123], v[48:63]
    ds_read_b64_tr_b16 v[72:73], v120 offset:4096
    ds_read_b64_tr_b16 v[74:75], v120 offset:4352
    buffer_load_dwordx4 v113, s[56:59], s81 offen offset:1024 lds
    s_waitcnt lgkmcnt(3)
    v_mfma_f32_32x32x16_bf16 v[32:47], a[64:67], a[68:71], v[32:47]
    s_waitcnt vmcnt(9)
    buffer_load_dwordx4 v114, s[56:59], s81 offen offset:2048 lds
    s_waitcnt lgkmcnt(2)
    v_mfma_f32_32x32x16_bf16 v[48:63], a[64:67], a[72:75], v[48:63]
    ds_read_b64_tr_b16 v[76:77], v120 offset:5120
    ds_read_b64_tr_b16 v[78:79], v120 offset:5376
    v_mov_b32 v95, 3
    ds_write_b32 v121, v95 offset:0
    s_waitcnt lgkmcnt(3)
    v_mfma_f32_32x32x16_bf16 v[0:15], v[72:75], a[0:3], 0
    s_waitcnt vmcnt(9)
    buffer_load_dwordx4 v115, s[56:59], s81 offen offset:3072 lds
    v_fma_f32 v96, v32, s74, -0.5
    v_fma_f32 v97, v33, s74, -0.5
    v_fma_f32 v98, v34, s74, -0.5
    v_fma_f32 v99, v35, s74, -0.5
    v_exp_f32 v96, v96
    v_exp_f32 v97, v97
    v_exp_f32 v98, v98
    v_exp_f32 v99, v99
    v_add_f32 v96, 0x3f3504f3, v96
    v_add_f32 v97, 0x3f3504f3, v97
    v_add_f32 v98, 0x3f3504f3, v98
    v_add_f32 v99, 0x3f3504f3, v99
    v_fma_f32 v96, v96, v96, 0.5
    v_fma_f32 v97, v97, v97, 0.5
    v_fma_f32 v98, v98, v98, 0.5
    v_fma_f32 v99, v99, v99, 0.5
    v_rcp_f32 v96, v96
    v_mfma_f32_32x32x16_bf16 v[16:31], v[72:75], a[8:11], 0
    ds_read_b64_tr_b16 v[80:81], v120 offset:6144
    ds_read_b64_tr_b16 v[82:83], v120 offset:6400
    v_rcp_f32 v97, v97
    v_rcp_f32 v98, v98
    v_rcp_f32 v99, v99
    v_fma_f32 v32, -v96, v32, v32
    v_fma_f32 v33, -v97, v33, v33
    v_fma_f32 v34, -v98, v34, v34
    v_fma_f32 v35, -v99, v35, v35
    v_cvt_pk_bf16_f32 v32, v32, v33
    v_cvt_pk_bf16_f32 v33, v34, v35
    v_fma_f32 v100, v36, s74, -0.5
    v_fma_f32 v101, v37, s74, -0.5
    v_fma_f32 v102, v38, s74, -0.5
    v_fma_f32 v103, v39, s74, -0.5
    v_exp_f32 v100, v100
    v_exp_f32 v101, v101
    v_and_b32 v95, 28, v127
    ds_read_b32 v123, v95 offset:0
    v_exp_f32 v102, v102
    s_waitcnt lgkmcnt(4)
    v_mfma_f32_32x32x16_bf16 v[0:15], v[76:79], a[4:7], v[0:15]
    s_waitcnt vmcnt(9)
    s_add_u32 m0, s76, 0x1400
    s_add_u32 s81, s81, 57344
    buffer_load_dwordx4 v112, s[56:59], s81 offen lds
    v_exp_f32 v103, v103
    v_add_f32 v100, 0x3f3504f3, v100
    v_add_f32 v101, 0x3f3504f3, v101
    v_add_f32 v102, 0x3f3504f3, v102
    v_add_f32 v103, 0x3f3504f3, v103
    v_fma_f32 v100, v100, v100, 0.5
    v_fma_f32 v101, v101, v101, 0.5
    v_fma_f32 v102, v102, v102, 0.5
    v_fma_f32 v103, v103, v103, 0.5
    v_rcp_f32 v100, v100
    v_rcp_f32 v101, v101
    s_waitcnt lgkmcnt(0)
    v_cmp_gt_u32 vcc, 3, v123
    s_cbranch_vccz CK_7
    s_mov_b32 s75, 65536
LS_8:
    ds_read_b32 v123, v95 offset:0
    s_sub_u32 s75, s75, 1
    s_cmp_eq_u32 s75, 0
    s_cbranch_scc1 LD_9
    s_waitcnt lgkmcnt(0)
    v_cmp_gt_u32 vcc, 3, v123
    s_cbranch_vccnz LS_8
LD_9:
    s_waitcnt lgkmcnt(0)
CK_7:
    s_add_u32 m0, s77, 0x0
    v_rcp_f32 v102, v102
    buffer_load_dwordx4 v113, s[56:59], s81 offen offset:1024 lds
    v_rcp_f32 v103, v103
    v_fma_f32 v36, -v100, v36, v36
    v_fma_f32 v37, -v101, v37, v37
    v_fma_f32 v38, -v102, v38, v38
    v_fma_f32 v39, -v103, v39, v39
    v_mfma_f32_32x32x16_bf16 v[16:31], v[76:79], a[12:15], v[16:31]
    ds_read_b64_tr_b16 v[84:85], v120 offset:7168
    ds_read_b64_tr_b16 v[86:87], v120 offset:7424
    buffer_load_dwordx4 v114, s[56:59], s81 offen offset:2048 lds
    buffer_load_dwordx4 v115, s[56:59], s81 offen offset:3072 lds
    v_cvt_pk_bf16_f32 v34, v36, v37
    v_cvt_pk_bf16_f32 v35, v38, v39
    v_fma_f32 v96, v40, s74, -0.5
    v_fma_f32 v97, v41, s74, -0.5
    v_fma_f32 v98, v42, s74, -0.5
    v_fma_f32 v99, v43, s74, -0.5
    v_exp_f32 v96, v96
    v_exp_f32 v97, v97
    v_exp_f32 v98, v98
    v_exp_f32 v99, v99
    v_add_f32 v96, 0x3f3504f3, v96
    v_add_f32 v97, 0x3f3504f3, v97
    s_waitcnt vmcnt(11)
    buffer_load_dwordx4 v112, s[56:59], s82 offen lds
    v_add_f32 v98, 0x3f3504f3, v98
    v_add_f32 v99, 0x3f3504f3, v99
    v_fma_f32 v96, v96, v96, 0.5
    v_fma_f32 v97, v97, v97, 0.5
    v_fma_f32 v98, v98, v98, 0.5
    v_mfma_f32_32x32x16_bf16 v[0:15], v[80:83], a[16:19], v[0:15]
    v_fma_f32 v99, v99, v99, 0.5
    v_rcp_f32 v96, v96
    v_rcp_f32 v97, v97
    v_rcp_f32 v98, v98
    v_rcp_f32 v99, v99
    s_waitcnt vmcnt(11)
    s_add_u32 m0, s77, 0xc00
    v_fma_f32 v40, -v96, v40, v40
    buffer_load_dwordx4 v113, s[56:59], s82 offen offset:1024 lds
    v_fma_f32 v41, -v97, v41, v41
    v_fma_f32 v42, -v98, v42, v42
    v_fma_f32 v43, -v99, v43, v43
    v_cvt_pk_bf16_f32 v36, v40, v41
    v_cvt_pk_bf16_f32 v37, v42, v43
    v_fma_f32 v100, v44, s74, -0.5
    v_fma_f32 v101, v45, s74, -0.5
    v_fma_f32 v102, v46, s74, -0.5
    v_fma_f32 v103, v47, s74, -0.5
    v_exp_f32 v100, v100
    v_exp_f32 v101, v101
    v_exp_f32 v102, v102
    v_mfma_f32_32x32x16_bf16 v[16:31], v[80:83], a[24:27], v[16:31]
    ds_read_b64_tr_b16 v[64:65], v120 offset:8192
    ds_read_b64_tr_b16 v[66:67], v120 offset:8448
    v_exp_f32 v103, v103
    s_waitcnt vmcnt(11)
    buffer_load_dwordx4 v114, s[56:59], s82 offen offset:2048 lds
    v_add_f32 v100, 0x3f3504f3, v100
    v_add_f32 v101, 0x3f3504f3, v101
    v_add_f32 v102, 0x3f3504f3, v102
    v_add_f32 v103, 0x3f3504f3, v103
    v_fma_f32 v100, v100, v100, 0.5
    v_fma_f32 v101, v101, v101, 0.5
    v_fma_f32 v102, v102, v102, 0.5
    v_fma_f32 v103, v103, v103, 0.5
    v_rcp_f32 v100, v100
    v_rcp_f32 v101, v101
    v_rcp_f32 v102, v102
    v_rcp_f32 v103, v103
    s_waitcnt vmcnt(11)
    buffer_load_dwordx4 v115, s[56:59], s82 offen offset:3072 lds
    v_fma_f32 v44, -v100, v44, v44
    v_fma_f32 v45, -v101, v45, v45
    v_fma_f32 v46, -v102, v46, v46
    v_fma_f32 v47, -v103, v47, v47
    s_waitcnt lgkmcnt(2)
    v_mfma_f32_32x32x16_bf16 v[0:15], v[84:87], a[20:23], v[0:15]
    v_cvt_pk_bf16_f32 v38, v44, v45
    v_cvt_pk_bf16_f32 v39, v46, v47
    ds_write_b128 v90, v[32:35] offset:11264
    ds_write_b128 v90, v[36:39] offset:12288
    v_mov_b32 v95, 4
    ds_write_b32 v121, v95 offset:0
    v_fma_f32 v96, v48, s74, -0.5
    v_fma_f32 v97, v49, s74, -0.5
    v_fma_f32 v98, v50, s74, -0.5
    s_waitcnt vmcnt(11)
    s_add_u32 m0, s77, 0x1c00
    s_add_u32 s82, s82, 57344
    buffer_load_dwordx4 v112, s[56:59], s82 offen lds
    v_fma_f32 v99, v51, s74, -0.5
    v_exp_f32 v96, v96
    v_exp_f32 v97, v97
    v_exp_f32 v98, v98
    v_exp_f32 v99, v99
    v_add_f32 v96, 0x3f3504f3, v96
    v_add_f32 v97, 0x3f3504f3, v97
    v_add_f32 v98, 0x3f3504f3, v98
    v_add_f32 v99, 0x3f3504f3, v99
    v_fma_f32 v96, v96, v96, 0.5
    v_mfma_f32_32x32x16_bf16 v[16:31], v[84:87], a[28:31], v[16:31]
    ds_read_b64_tr_b16 v[68:69], v120 offset:9216
    ds_read_b64_tr_b16 v[70:71], v120 offset:9472
    v_fma_f32 v97, v97, v97, 0.5
    s_waitcnt vmcnt(11)
    buffer_load_dwordx4 v113, s[56:59], s82 offen offset:1024 lds
    v_fma_f32 v98, v98, v98, 0.5
    v_fma_f32 v99, v99, v99, 0.5
    v_rcp_f32 v96, v96
    v_rcp_f32 v97, v97
    v_rcp_f32 v98, v98
    v_rcp_f32 v99, v99
    v_fma_f32 v48, -v96, v48, v48
    v_fma_f32 v49, -v97, v49, v49
    v_fma_f32 v50, -v98, v50, v50
    v_fma_f32 v51, -v99, v51, v51
    v_cvt_pk_bf16_f32 v48, v48, v49
    v_cvt_pk_bf16_f32 v49, v50, v51
    s_waitcnt vmcnt(11)
    buffer_load_dwordx4 v114, s[56:59], s82 offen offset:2048 lds
    v_fma_f32 v100, v52, s74, -0.5
    v_fma_f32 v101, v53, s74, -0.5
    v_fma_f32 v102, v54, s74, -0.5
    v_fma_f32 v103, v55, s74, -0.5
    s_waitcnt lgkmcnt(5)
    v_mfma_f32_32x32x16_bf16 v[0:15], v[64:67], a[32:35], v[0:15]
    v_exp_f32 v100, v100
    v_exp_f32 v101, v101
    v_exp_f32 v102, v102
    v_exp_f32 v103, v103
    v_add_f32 v100, 0x3f3504f3, v100
    s_waitcnt vmcnt(11)
    buffer_load_dwordx4 v115, s[56:59], s82 offen offset:3072 lds
    v_add_f32 v101, 0x3f3504f3, v101
    v_add_f32 v102, 0x3f3504f3, v102
    v_add_f32 v103, 0x3f3504f3, v103
    v_fma_f32 v100, v100, v100, 0.5
    v_fma_f32 v101, v101, v101, 0.5
    v_fma_f32 v102, v102, v102, 0.5
    v_fma_f32 v103, v103, v103, 0.5
    v_rcp_f32 v100, v100
    v_rcp_f32 v101, v101
    v_rcp_f32 v102, v102
    v_rcp_f32 v103, v103
    v_fma_f32 v52, -v100, v52, v52
    s_waitcnt vmcnt(11)
    s_add_u32 m0, s77, 0x2c00
    s_add_u32 s82, s82, 57344
    buffer_load_dwordx4 v112, s[56:59], s82 offen lds
    v_mfma_f32_32x32x16_bf16 v[16:31], v[64:67], a[40:43], v[16:31]
    ds_read_b64_tr_b16 v[72:73], v120 offset:10240
    ds_read_b64_tr_b16 v[74:75], v120 offset:10496
    v_fma_f32 v53, -v101, v53, v53
    v_fma_f32 v54, -v102, v54, v54
    v_fma_f32 v55, -v103, v55, v55
    v_cvt_pk_bf16_f32 v50, v52, v53
    v_cvt_pk_bf16_f32 v51, v54, v55
    v_fma_f32 v96, v56, s74, -0.5
    v_fma_f32 v97, v57, s74, -0.5
    v_fma_f32 v98, v58, s74, -0.5
    v_fma_f32 v99, v59, s74, -0.5
    v_exp_f32 v96, v96
    v_exp_f32 v97, v97
    s_waitcnt vmcnt(11)
    buffer_load_dwordx4 v113, s[56:59], s82 offen offset:1024 lds
    v_exp_f32 v98, v98
    v_exp_f32 v99, v99
    ds_read_b32 v123, v122 offset:0
    v_add_f32 v96, 0x3f3504f3, v96
    v_add_f32 v97, 0x3f3504f3, v97
    v_add_f32 v98, 0x3f3504f3, v98
    v_add_f32 v99, 0x3f3504f3, v99
    v_fma_f32 v96, v96, v96, 0.5
    v_fma_f32 v97, v97, v97, 0.5
    v_fma_f32 v98, v98, v98, 0.5
    v_fma_f32 v99, v99, v99, 0.5
    v_rcp_f32 v96, v96
    v_rcp_f32 v97, v97
    s_waitcnt vmcnt(11)
    buffer_load_dwordx4 v114, s[56:59], s82 offen offset:2048 lds
    v_rcp_f32 v98, v98
    v_rcp_f32 v99, v99
    s_waitcnt lgkmcnt(0)
    v_cmp_gt_u32 vcc, 4, v123
    s_cbranch_vccz CK_10
    s_mov_b32 s75, 65536
LS_11:
    ds_read_b32 v123, v122 offset:0
    s_sub_u32 s75, s75, 1
    s_cmp_eq_u32 s75, 0
    s_cbranch_scc1 LD_12
    s_waitcnt lgkmcnt(0)
    v_cmp_gt_u32 vcc, 4, v123
    s_cbranch_vccnz LS_11
LD_12:
    s_waitcnt lgkmcnt(0)
CK_10:
    s_waitcnt vmcnt(11)
    s_add_u32 m0, s76, 0xc00
    v_fma_f32 v56, -v96, v56, v56
    buffer_load_dwordx4 v115, s[56:59], s82 offen offset:3072 lds
    v_fma_f32 v57, -v97, v57, v57
    v_fma_f32 v58, -v98, v58, v58
    ds_read_b128 a[64:67], v88 offset:11264
    v_fma_f32 v59, -v99, v59, v59
    v_cvt_pk_bf16_f32 v52, v56, v57
    v_cvt_pk_bf16_f32 v53, v58, v59
    ds_read_b128 a[68:71], v89 offset:11264
    v_fma_f32 v100, v60, s74, -0.5
    v_fma_f32 v101, v61, s74, -0.5
    v_fma_f32 v102, v62, s74, -0.5
    ds_read_b128 a[80:83], v88 offset:26624
    v_fma_f32 v103, v63, s74, -0.5
    v_exp_f32 v100, v100
    v_exp_f32 v101, v101
    s_waitcnt vmcnt(11)
    s_add_u32 m0, s76, 0x1c00
    s_add_u32 s82, s82, 57344
    buffer_load_dwordx4 v112, s[56:59], s82 offen lds
    ds_read_b128 a[84:87], v89 offset:26624
    v_exp_f32 v102, v102
    v_exp_f32 v103, v103
    v_add_f32 v100, 0x3f3504f3, v100
    ds_read_b128 a[96:99], v88 offset:41984
    v_add_f32 v101, 0x3f3504f3, v101
    v_add_f32 v102, 0x3f3504f3, v102
    v_add_f32 v103, 0x3f3504f3, v103
    ds_read_b128 a[100:103], v89 offset:41984
    v_fma_f32 v100, v100, v100, 0.5
    v_fma_f32 v101, v101, v101, 0.5
    v_fma_f32 v102, v102, v102, 0.5
    ds_read_b128 a[112:115], v88 offset:57344
    v_fma_f32 v103, v103, v103, 0.5
    s_waitcnt vmcnt(11)
    buffer_load_dwordx4 v113, s[56:59], s82 offen offset:1024 lds
    v_rcp_f32 v100, v100
    v_rcp_f32 v101, v101
    ds_read_b128 a[116:119], v89 offset:57344
    v_rcp_f32 v102, v102
    v_rcp_f32 v103, v103
    v_fma_f32 v60, -v100, v60, v60
    v_fma_f32 v61, -v101, v61, v61
    v_fma_f32 v62, -v102, v62, v62
    v_fma_f32 v63, -v103, v63, v63
    v_cvt_pk_bf16_f32 v54, v60, v61
    v_cvt_pk_bf16_f32 v55, v62, v63
    ds_write_b128 v90, v[48:51] offset:13312
    ds_write_b128 v90, v[52:55] offset:14336
    v_mov_b32 v95, 5
    ds_write_b32 v121, v95 offset:0
    v_mfma_f32_32x32x16_bf16 v[0:15], v[68:71], a[36:39], v[0:15]
    ds_read_b32 v123, v122 offset:0
    s_waitcnt vmcnt(11)
    buffer_load_dwordx4 v114, s[56:59], s82 offen offset:2048 lds
    v_mfma_f32_32x32x16_bf16 v[16:31], v[68:71], a[44:47], v[16:31]
    ds_read_b64_tr_b16 v[76:77], v120 offset:0
    ds_read_b64_tr_b16 v[78:79], v120 offset:256
    s_waitcnt lgkmcnt(2)
    v_cmp_gt_u32 vcc, 5, v123
    s_cbranch_vccz CK_13
    s_mov_b32 s75, 65536
LS_14:
    ds_read_b32 v123, v122 offset:0
    s_sub_u32 s75, s75, 1
    s_cmp_eq_u32 s75, 0
    s_cbranch_scc1 LD_15
    s_waitcnt lgkmcnt(0)
    v_cmp_gt_u32 vcc, 5, v123
    s_cbranch_vccnz LS_14
LD_15:
    s_waitcnt lgkmcnt(0)
CK_13:
    ds_read_b128 a[72:75], v88 offset:13312
    ds_read_b128 a[76:79], v89 offset:13312
    v_mfma_f32_32x32x16_bf16 v[0:15], v[72:75], a[48:51], v[0:15]
    s_waitcnt vmcnt(11)
    buffer_load_dwordx4 v115, s[56:59], s82 offen offset:3072 lds
    ds_read_b128 a[88:91], v88 offset:28672
    ds_read_b128 a[92:95], v89 offset:28672
    v_mfma_f32_32x32x16_bf16 v[16:31], v[72:75], a[56:59], v[16:31]
    ds_read_b64_tr_b16 v[80:81], v120 offset:1024
    ds_read_b64_tr_b16 v[82:83], v120 offset:1280
    ds_read_b128 a[104:107], v88 offset:44032
    ds_read_b128 a[108:111], v89 offset:44032
    ds_read_b128 a[120:123], v88 offset:59392
    s_waitcnt lgkmcnt(9)
    v_mfma_f32_32x32x16_bf16 v[0:15], v[76:79], a[52:55], v[0:15]
    s_waitcnt vmcnt(11)
    s_add_u32 m0, s76, 0x0
    s_nop 0
    buffer_load_dwordx4 v112, s[56:59], s83 offen lds
    ds_read_b128 a[124:127], v89 offset:59392
    v_add_u32 v108, 0, v112
    v_mfma_f32_32x32x16_bf16 v[16:31], v[76:79], a[60:63], v[16:31]
    ds_read_b64_tr_b16 v[84:85], v120 offset:2048
    ds_read_b64_tr_b16 v[86:87], v120 offset:2304
    v_add_u32 v109, 27648, v112
    v_add_u32 v110, 55296, v112
    v_add_u32 v111, 82944, v112
    s_waitcnt lgkmcnt(6)
    v_mfma_f32_32x32x16_bf16 v[0:15], v[80:83], a[64:67], v[0:15]
    v_mfma_f32_32x32x16_bf16 v[16:31], v[80:83], a[72:75], v[16:31]
    ds_read_b64_tr_b16 v[64:65], v120 offset:3072
    ds_read_b64_tr_b16 v[66:67], v120 offset:3328
    s_waitcnt lgkmcnt(2)
    v_mfma_f32_32x32x16_bf16 v[0:15], v[84:87], a[68:71], v[0:15]
    buffer_load_dwordx4 v113, s[56:59], s83 offen offset:1024 lds
    v_mov_b32 v95, 0
    s_mov_b32 s75, 65536
    s_branch EM_17
EP_16:
    ds_read_b32 v93, v95 offset:68
    s_waitcnt lgkmcnt(0)
EM_17:
    v_readfirstlane_b32 s72, v93
    s_sub_u32 s75, s75, 1
    s_cmp_eq_u32 s75, 0
    s_cbranch_scc1 ED_18
    s_cmp_lg_u32 s72, 0
    s_cbranch_scc0 EP_16
ED_18:
    s_xor_b32 s95, s95, s72
    v_cmp_ne_u32 vcc, s95, v94
    s_cmp_eq_u64 vcc, 0
    s_cselect_b32 s88, 32, 0
    s_xor_b32 s10, s72, 3
    v_lshlrev_b32 v93, 2, v122
    v_lshlrev_b32 v119, 1, v122
    v_mfma_f32_32x32x16_bf16 v[16:31], v[84:87], a[76:79], v[16:31]
    ds_read_b64_tr_b16 v[68:69], v120 offset:4096
    ds_read_b64_tr_b16 v[70:71], v120 offset:4352
    v_bfe_u32 v119, s72, v119, 8
    v_lshl_or_b32 v119, v119, 15, v119
    v_and_b32 v116, 0x10001, v119
    s_waitcnt lgkmcnt(2)
    v_mfma_f32_32x32x16_bf16 v[0:15], v[64:67], a[80:83], v[0:15]
    v_lshrrev_b32 v117, 2, v119
    v_lshrrev_b32 v118, 4, v119
    v_mfma_f32_32x32x16_bf16 v[16:31], v[64:67], a[88:91], v[16:31]
    ds_read_b64_tr_b16 v[72:73], v120 offset:5120
    ds_read_b64_tr_b16 v[74:75], v120 offset:5376
    v_lshrrev_b32 v119, 6, v119
    v_and_b32 v117, 0x10001, v117
    v_and_b32 v118, 0x10001, v118
    s_waitcnt lgkmcnt(2)
    v_mfma_f32_32x32x16_bf16 v[0:15], v[68:71], a[84:87], v[0:15]
    buffer_load_dwordx4 v114, s[56:59], s83 offen offset:2048 lds
    v_and_b32 v119, 0x10001, v119
    v_and_b32 v104, 28, v127
    v_mfma_f32_32x32x16_bf16 v[16:31], v[68:71], a[92:95], v[16:31]
    ds_read_b64_tr_b16 v[76:77], v91 offset:1024
    ds_read_b64_tr_b16 v[78:79], v91 offset:1280
    v_and_b32 v105, 0x70, v124
    v_mul_u32_u24 v104, 896, v104
    v_add_u32 v104, v104, v105
    s_waitcnt lgkmcnt(2)
    v_mfma_f32_32x32x16_bf16 v[0:15], v[72:75], a[96:99], v[0:15]
    buffer_load_dwordx4 v115, s[56:59], s83 offen offset:3072 lds
    v_mfma_f32_32x32x16_bf16 v[16:31], v[72:75], a[104:107], v[16:31]
    ds_read_b64_tr_b16 v[80:81], v91 offset:2048
    ds_read_b64_tr_b16 v[82:83], v91 offset:2304
    s_waitcnt lgkmcnt(2)
    v_mfma_f32_32x32x16_bf16 v[0:15], v[76:79], a[100:103], v[0:15]
    v_mfma_f32_32x32x16_bf16 v[16:31], v[76:79], a[108:111], v[16:31]
    ds_read_b64_tr_b16 v[84:85], v91 offset:3072
    ds_read_b64_tr_b16 v[86:87], v91 offset:3328
    s_waitcnt lgkmcnt(2)
    v_mfma_f32_32x32x16_bf16 v[0:15], v[80:83], a[112:115], v[0:15]
    s_add_u32 m0, s76, 0x1000
    s_add_u32 s83, s83, 57344
    buffer_load_dwordx4 v112, s[56:59], s83 offen lds
    v_mfma_f32_32x32x16_bf16 v[16:31], v[80:83], a[120:123], v[16:31]
    ds_read_b64_tr_b16 v[64:65], v91 offset:0
    ds_read_b64_tr_b16 v[66:67], v91 offset:256
    s_waitcnt lgkmcnt(2)
    v_mfma_f32_32x32x16_bf16 v[0:15], v[84:87], a[116:119], v[0:15]
    buffer_load_dwordx4 v113, s[56:59], s83 offen offset:1024 lds
    v_mfma_f32_32x32x16_bf16 v[16:31], v[84:87], a[124:127], v[16:31]
    ds_read_b64_tr_b16 v[68:69], v91 offset:4096
    ds_read_b64_tr_b16 v[70:71], v91 offset:4352
    s_waitcnt lgkmcnt(2)
    v_mfma_f32_32x32x16_bf16 v[32:47], v[64:67], a[0:3], 0
    v_mfma_f32_32x32x16_bf16 v[48:63], v[64:67], a[8:11], 0
    ds_read_b64_tr_b16 v[72:73], v91 offset:5120
    ds_read_b64_tr_b16 v[74:75], v91 offset:5376
    s_nop 2
    v_cvt_pk_f16_f32 v0, v0, v1
    v_cvt_pk_f16_f32 v1, v2, v3
    v_and_or_b32 v0, v0, s89, v116
    s_waitcnt lgkmcnt(2)
    v_mfma_f32_32x32x16_bf16 v[32:47], v[68:71], a[4:7], v[32:47]
    s_add_u32 m0, s77, 0x0
    v_cvt_pk_f16_f32 v2, v4, v5
    buffer_load_dwordx4 v114, s[56:59], s83 offen offset:2048 lds
    v_and_or_b32 v1, v1, s89, v117
    v_cvt_pk_f16_f32 v3, v6, v7
    v_mfma_f32_32x32x16_bf16 v[48:63], v[68:71], a[12:15], v[48:63]
    ds_read_b64_tr_b16 v[76:77], v91 offset:6144
    ds_read_b64_tr_b16 v[78:79], v91 offset:6400
    v_and_or_b32 v2, v2, s89, v118
    v_cvt_pk_f16_f32 v4, v8, v9
    v_and_or_b32 v3, v3, s89, v119
    s_waitcnt lgkmcnt(2)
    v_mfma_f32_32x32x16_bf16 v[32:47], v[72:75], a[16:19], v[32:47]
    buffer_load_dwordx4 v115, s[56:59], s83 offen offset:3072 lds
    v_cvt_pk_f16_f32 v5, v10, v11
    v_and_or_b32 v4, v4, s89, v116
    v_mfma_f32_32x32x16_bf16 v[48:63], v[72:75], a[24:27], v[48:63]
    ds_read_b64_tr_b16 v[80:81], v91 offset:7168
    ds_read_b64_tr_b16 v[82:83], v91 offset:7424
    v_cvt_pk_f16_f32 v6, v12, v13
    v_and_or_b32 v5, v5, s89, v117
    v_cvt_pk_f16_f32 v7, v14, v15
    s_waitcnt lgkmcnt(2)
    v_mfma_f32_32x32x16_bf16 v[32:47], v[76:79], a[20:23], v[32:47]
    s_waitcnt vmcnt(18)
    v_and_or_b32 v6, v6, s89, v118
    v_and_or_b32 v7, v7, s89, v119
    v_mfma_f32_32x32x16_bf16 v[48:63], v[76:79], a[28:31], v[48:63]
    ds_read_b64_tr_b16 v[84:85], v91 offset:8192
    ds_read_b64_tr_b16 v[86:87], v91 offset:8448
    s_cmp_lg_u32 s88, 32
    s_cbranch_scc1 SC_19
    buffer_store_dwordx4 v[0:3], v124, s[44:47], s85 offen offset:0
    buffer_store_dwordx4 v[4:7], v124, s[44:47], s85 offen offset:128
SB_20:
    v_cvt_pk_f16_f32 v16, v16, v17
    v_cvt_pk_f16_f32 v17, v18, v19
    s_waitcnt lgkmcnt(2)
    v_mfma_f32_32x32x16_bf16 v[32:47], v[80:83], a[32:35], v[32:47]
    s_waitcnt vmcnt(19)
    s_add_u32 m0, s77, 0x400
    s_add_u32 s83, s83, 57344
    buffer_load_dwordx4 v112, s[56:59], s83 offen lds
    v_and_or_b32 v16, v16, s89, v116
    v_cvt_pk_f16_f32 v18, v20, v21
    v_mfma_f32_32x32x16_bf16 v[48:63], v[80:83], a[40:43], v[48:63]
    ds_read_b64_tr_b16 v[64:65], v91 offset:9216
    ds_read_b64_tr_b16 v[66:67], v91 offset:9472
    v_and_or_b32 v17, v17, s89, v117
    v_cvt_pk_f16_f32 v19, v22, v23
    v_and_or_b32 v18, v18, s89, v118
    s_waitcnt lgkmcnt(2)
    v_mfma_f32_32x32x16_bf16 v[32:47], v[84:87], a[36:39], v[32:47]
    s_waitcnt vmcnt(19)
    s_add_u32 m0, s77, 0xc00
    v_cvt_pk_f16_f32 v20, v24, v25
    buffer_load_dwordx4 v113, s[56:59], s83 offen offset:1024 lds
    v_and_or_b32 v19, v19, s89, v119
    v_cvt_pk_f16_f32 v21, v26, v27
    v_mfma_f32_32x32x16_bf16 v[48:63], v[84:87], a[44:47], v[48:63]
    ds_read_b64_tr_b16 v[68:69], v91 offset:10240
    ds_read_b64_tr_b16 v[70:71], v91 offset:10496
    v_and_or_b32 v20, v20, s89, v116
    v_cvt_pk_f16_f32 v22, v28, v29
    v_and_or_b32 v21, v21, s89, v117
    s_waitcnt lgkmcnt(2)
    v_mfma_f32_32x32x16_bf16 v[32:47], v[64:67], a[48:51], v[32:47]
    s_waitcnt vmcnt(19)
    v_cvt_pk_f16_f32 v23, v30, v31
    v_and_or_b32 v22, v22, s89, v118
    v_mfma_f32_32x32x16_bf16 v[48:63], v[64:67], a[56:59], v[48:63]
    ds_read_b64_tr_b16 v[72:73], v91 offset:11264
    ds_read_b64_tr_b16 v[74:75], v91 offset:11520
    v_and_or_b32 v23, v23, s89, v119
    s_cmp_lg_u32 s88, 32
    s_cbranch_scc1 SC_21
    buffer_store_dwordx4 v[16:19], v124, s[44:47], s85 offen offset:1024
    buffer_store_dwordx4 v[20:23], v124, s[44:47], s85 offen offset:1152
SB_22:
    v_mov_b32 v95, 6
    ds_write_b32 v121, v95 offset:0
    s_waitcnt lgkmcnt(3)
    v_mfma_f32_32x32x16_bf16 v[32:47], v[68:71], a[52:55], v[32:47]
    s_waitcnt vmcnt(20)
    buffer_load_dwordx4 v114, s[56:59], s83 offen offset:2048 lds
    v_mfma_f32_32x32x16_bf16 v[48:63], v[68:71], a[60:63], v[48:63]
    ds_read_b64_tr_b16 v[76:77], v91 offset:12288
    ds_read_b64_tr_b16 v[78:79], v91 offset:12544
    s_waitcnt lgkmcnt(3)
    v_mfma_f32_32x32x16_bf16 v[32:47], v[72:75], a[64:67], v[32:47]
    s_waitcnt vmcnt(20)
    buffer_load_dwordx4 v115, s[56:59], s83 offen offset:3072 lds
    v_mfma_f32_32x32x16_bf16 v[48:63], v[72:75], a[72:75], v[48:63]
    ds_read_b64_tr_b16 v[80:81], v91 offset:13312
    ds_read_b64_tr_b16 v[82:83], v91 offset:13568
    s_waitcnt lgkmcnt(2)
    v_mfma_f32_32x32x16_bf16 v[32:47], v[76:79], a[68:71], v[32:47]
    s_waitcnt vmcnt(20)
    v_mfma_f32_32x32x16_bf16 v[48:63], v[76:79], a[76:79], v[48:63]
    ds_read_b64_tr_b16 v[84:85], v120 offset:6144
    ds_read_b64_tr_b16 v[86:87], v120 offset:6400
    s_waitcnt lgkmcnt(2)
    v_mfma_f32_32x32x16_bf16 v[32:47], v[80:83], a[80:83], v[32:47]
    s_waitcnt vmcnt(19)
    s_add_u32 m0, s77, 0x0
    s_add_u32 s83, s83, 57344
    buffer_load_dwordx4 v112, s[56:59], s83 offen lds
    v_mfma_f32_32x32x16_bf16 v[48:63], v[80:83], a[88:91], v[48:63]
    ds_read_b64_tr_b16 v[64:65], v120 offset:7168
    ds_read_b64_tr_b16 v[66:67], v120 offset:7424
    s_waitcnt lgkmcnt(2)
    v_mfma_f32_32x32x16_bf16 v[32:47], v[84:87], a[84:87], v[32:47]
    s_waitcnt vmcnt(19)
    s_add_u32 m0, s77, 0x1800
    s_nop 0
    buffer_load_dwordx4 v113, s[56:59], s83 offen offset:1024 lds
    v_mfma_f32_32x32x16_bf16 v[48:63], v[84:87], a[92:95], v[48:63]
    ds_read_b64_tr_b16 v[68:69], v120 offset:8192
    ds_read_b64_tr_b16 v[70:71], v120 offset:8448
    s_waitcnt lgkmcnt(2)
    v_mfma_f32_32x32x16_bf16 v[32:47], v[64:67], a[96:99], v[32:47]
    s_waitcnt vmcnt(19)
    v_mfma_f32_32x32x16_bf16 v[48:63], v[64:67], a[104:107], v[48:63]
    ds_read_b64_tr_b16 v[72:73], v120 offset:9216
    ds_read_b64_tr_b16 v[74:75], v120 offset:9472
    s_waitcnt lgkmcnt(2)
    v_mfma_f32_32x32x16_bf16 v[32:47], v[68:71], a[100:103], v[32:47]
    s_waitcnt vmcnt(18)
    buffer_load_dwordx4 v114, s[56:59], s83 offen offset:2048 lds
    v_mfma_f32_32x32x16_bf16 v[48:63], v[68:71], a[108:111], v[48:63]
    ds_read_b64_tr_b16 v[76:77], v120 offset:10240
    ds_read_b64_tr_b16 v[78:79], v120 offset:10496
    s_waitcnt lgkmcnt(2)
    v_mfma_f32_32x32x16_bf16 v[32:47], v[72:75], a[112:115], v[32:47]
    s_waitcnt vmcnt(18)
    v_mfma_f32_32x32x16_bf16 v[48:63], v[72:75], a[120:123], v[48:63]
    ds_read_b64_tr_b16 v[80:81], v120 offset:0
    ds_read_b64_tr_b16 v[82:83], v120 offset:256
    s_waitcnt lgkmcnt(2)
    v_mfma_f32_32x32x16_bf16 v[32:47], v[76:79], a[116:119], v[32:47]
    s_waitcnt vmcnt(17)
    buffer_load_dwordx4 v115, s[56:59], s83 offen offset:3072 lds
    v_mfma_f32_32x32x16_bf16 v[48:63], v[76:79], a[124:127], v[48:63]
    ds_read_b64_tr_b16 v[84:85], v120 offset:1024
    ds_read_b64_tr_b16 v[86:87], v120 offset:1280
    s_waitcnt lgkmcnt(2)
    v_mfma_f32_32x32x16_bf16 v[0:15], v[80:83], a[0:3], 0
    s_waitcnt vmcnt(17)
    s_add_u32 m0, s77, 0x2800
    s_nop 0
    buffer_load_dwordx4 v108, s[56:59], s84 offen lds
    v_mfma_f32_32x32x16_bf16 v[16:31], v[80:83], a[8:11], 0
    ds_read_b64_tr_b16 v[64:65], v120 offset:2048
    ds_read_b64_tr_b16 v[66:67], v120 offset:2304
    v_cvt_pk_f16_f32 v32, v32, v33
    v_cvt_pk_f16_f32 v33, v34, v35
    v_and_or_b32 v32, v32, s89, v116
    s_waitcnt lgkmcnt(2)
    v_mfma_f32_32x32x16_bf16 v[0:15], v[84:87], a[4:7], v[0:15]
    s_waitcnt vmcnt(17)
    v_cvt_pk_f16_f32 v34, v36, v37
    v_and_or_b32 v33, v33, s89, v117
    v_mfma_f32_32x32x16_bf16 v[16:31], v[84:87], a[12:15], v[16:31]
    ds_read_b64_tr_b16 v[68:69], v120 offset:3072
    ds_read_b64_tr_b16 v[70:71], v120 offset:3328
    v_cvt_pk_f16_f32 v35, v38, v39
    v_and_or_b32 v34, v34, s89, v118
    v_cvt_pk_f16_f32 v36, v40, v41
    s_waitcnt lgkmcnt(2)
    v_mfma_f32_32x32x16_bf16 v[0:15], v[64:67], a[16:19], v[0:15]
    s_waitcnt vmcnt(16)
    buffer_load_dwordx4 v109, s[56:59], s84 offen offset:1024 lds
    v_and_or_b32 v35, v35, s89, v119
    v_cvt_pk_f16_f32 v37, v42, v43
    v_mfma_f32_32x32x16_bf16 v[16:31], v[64:67], a[24:27], v[16:31]
    ds_read_b64_tr_b16 v[72:73], v120 offset:4096
    ds_read_b64_tr_b16 v[74:75], v120 offset:4352
    v_and_or_b32 v36, v36, s89, v116
    v_cvt_pk_f16_f32 v38, v44, v45
    v_and_or_b32 v37, v37, s89, v117
    s_waitcnt lgkmcnt(2)
    v_mfma_f32_32x32x16_bf16 v[0:15], v[68:71], a[20:23], v[0:15]
    s_waitcnt vmcnt(16)
    buffer_load_dwordx4 v110, s[56:59], s84 offen offset:2048 lds
    v_cvt_pk_f16_f32 v39, v46, v47
    v_and_or_b32 v38, v38, s89, v118
    v_mfma_f32_32x32x16_bf16 v[16:31], v[68:71], a[28:31], v[16:31]
    ds_read_b64_tr_b16 v[76:77], v120 offset:5120
    ds_read_b64_tr_b16 v[78:79], v120 offset:5376
    v_and_or_b32 v39, v39, s89, v119
    s_cmp_lg_u32 s88, 32
    s_cbranch_scc1 SC_23
    buffer_store_dwordx4 v[32:35], v104, s[60:63], s86 offen offset:0
    buffer_store_dwordx4 v[36:39], v104, s[60:63], s86 offen offset:896
SB_24:
    v_cvt_pk_f16_f32 v48, v48, v49
    s_waitcnt lgkmcnt(2)
    v_mfma_f32_32x32x16_bf16 v[0:15], v[72:75], a[32:35], v[0:15]
    s_waitcnt vmcnt(18)
    v_cvt_pk_f16_f32 v49, v50, v51
    v_and_or_b32 v48, v48, s89, v116
    v_mfma_f32_32x32x16_bf16 v[16:31], v[72:75], a[40:43], v[16:31]
    ds_read_b64_tr_b16 v[80:81], v91 offset:2048
    ds_read_b64_tr_b16 v[82:83], v91 offset:2304
    v_cvt_pk_f16_f32 v50, v52, v53
    v_and_or_b32 v49, v49, s89, v117
    v_cvt_pk_f16_f32 v51, v54, v55
    s_waitcnt lgkmcnt(2)
    v_mfma_f32_32x32x16_bf16 v[0:15], v[76:79], a[36:39], v[0:15]
    s_waitcnt vmcnt(17)
    buffer_load_dwordx4 v111, s[56:59], s84 offen offset:3072 lds
    v_and_or_b32 v50, v50, s89, v118
    v_cvt_pk_f16_f32 v52, v56, v57
    v_mfma_f32_32x32x16_bf16 v[16:31], v[76:79], a[44:47], v[16:31]
    ds_read_b64_tr_b16 v[84:85], v91 offset:3072
    ds_read_b64_tr_b16 v[86:87], v91 offset:3328
    v_and_or_b32 v51, v51, s89, v119
    v_cvt_pk_f16_f32 v53, v58, v59
    v_and_or_b32 v52, v52, s89, v116
    s_waitcnt lgkmcnt(2)
    v_mfma_f32_32x32x16_bf16 v[0:15], v[80:83], a[48:51], v[0:15]
    s_waitcnt vmcnt(15)
    s_add_u32 m0, s76, 0x1800
    s_add_u32 s84, s84, 114688
    buffer_load_dwordx4 v108, s[56:59], s84 offen lds
    v_cvt_pk_f16_f32 v54, v60, v61
    v_and_or_b32 v53, v53, s89, v117
    v_mfma_f32_32x32x16_bf16 v[16:31], v[80:83], a[56:59], v[16:31]
    ds_read_b64_tr_b16 v[64:65], v91 offset:1024
    ds_read_b64_tr_b16 v[66:67], v91 offset:1280
    s_add_u32 s86, s86, 28672
    v_cvt_pk_f16_f32 v55, v62, v63
    v_and_or_b32 v54, v54, s89, v118
    s_waitcnt lgkmcnt(2)
    v_mfma_f32_32x32x16_bf16 v[0:15], v[84:87], a[52:55], v[0:15]
    s_waitcnt vmcnt(15)
    v_and_or_b32 v55, v55, s89, v119
    s_cmp_lg_u32 s88, 32
    s_cbranch_scc1 SC_25
    buffer_store_dwordx4 v[48:51], v104, s[60:63], s86 offen offset:0
    buffer_store_dwordx4 v[52:55], v104, s[60:63], s86 offen offset:896
SB_26:
    v_mfma_f32_32x32x16_bf16 v[16:31], v[84:87], a[60:63], v[16:31]
    ds_read_b64_tr_b16 v[68:69], v91 offset:4096
    ds_read_b64_tr_b16 v[70:71], v91 offset:4352
    v_mov_b32 v95, 7
    ds_write_b32 v121, v95 offset:0
    v_xor_b32 v116, 0x10001, v116
    s_waitcnt lgkmcnt(3)
    v_mfma_f32_32x32x16_bf16 v[0:15], v[64:67], a[64:67], v[0:15]
    s_waitcnt vmcnt(14)
    buffer_load_dwordx4 v109, s[56:59], s84 offen offset:1024 lds
    v_xor_b32 v117, 0x10001, v117
    v_xor_b32 v118, 0x10001, v118
    v_mfma_f32_32x32x16_bf16 v[16:31], v[64:67], a[72:75], v[16:31]
    ds_read_b64_tr_b16 v[72:73], v91 offset:5120
    ds_read_b64_tr_b16 v[74:75], v91 offset:5376
    v_xor_b32 v119, 0x10001, v119
    s_waitcnt lgkmcnt(3)
    v_mfma_f32_32x32x16_bf16 v[0:15], v[68:71], a[68:71], v[0:15]
    s_waitcnt vmcnt(14)
    buffer_load_dwordx4 v110, s[56:59], s84 offen offset:2048 lds
    v_mfma_f32_32x32x16_bf16 v[16:31], v[68:71], a[76:79], v[16:31]
    ds_read_b64_tr_b16 v[76:77], v91 offset:6144
    ds_read_b64_tr_b16 v[78:79], v91 offset:6400
    s_waitcnt lgkmcnt(2)
    v_mfma_f32_32x32x16_bf16 v[0:15], v[72:75], a[80:83], v[0:15]
    s_waitcnt vmcnt(14)
    v_mfma_f32_32x32x16_bf16 v[16:31], v[72:75], a[88:91], v[16:31]
    ds_read_b64_tr_b16 v[80:81], v91 offset:0
    ds_read_b64_tr_b16 v[82:83], v91 offset:256
    s_waitcnt lgkmcnt(2)
    v_mfma_f32_32x32x16_bf16 v[0:15], v[76:79], a[84:87], v[0:15]
    s_waitcnt vmcnt(13)
    buffer_load_dwordx4 v111, s[56:59], s84 offen offset:3072 lds
    v_mfma_f32_32x32x16_bf16 v[16:31], v[76:79], a[92:95], v[16:31]
    ds_read_b64_tr_b16 v[84:85], v91 offset:7168
    ds_read_b64_tr_b16 v[86:87], v91 offset:7424
    s_waitcnt lgkmcnt(2)
    v_mfma_f32_32x32x16_bf16 v[0:15], v[80:83], a[96:99], v[0:15]
    s_waitcnt vmcnt(13)
    v_mfma_f32_32x32x16_bf16 v[16:31], v[80:83], a[104:107], v[16:31]
    ds_read_b64_tr_b16 v[64:65], v91 offset:8192
    ds_read_b64_tr_b16 v[66:67], v91 offset:8448
    buffer_load_dword v94, v93, s[44:47], s9 offen offset:64 sc1
    s_waitcnt lgkmcnt(2)
    v_mfma_f32_32x32x16_bf16 v[0:15], v[84:87], a[100:103], v[0:15]
    s_waitcnt vmcnt(13)
    v_mfma_f32_32x32x16_bf16 v[16:31], v[84:87], a[108:111], v[16:31]
    ds_read_b64_tr_b16 v[68:69], v91 offset:9216
    ds_read_b64_tr_b16 v[70:71], v91 offset:9472
    s_waitcnt lgkmcnt(2)
    v_mfma_f32_32x32x16_bf16 v[0:15], v[64:67], a[112:115], v[0:15]
    s_waitcnt vmcnt(12)
    v_mfma_f32_32x32x16_bf16 v[16:31], v[64:67], a[120:123], v[16:31]
    ds_read_b64_tr_b16 v[72:73], v91 offset:10240
    ds_read_b64_tr_b16 v[74:75], v91 offset:10496
    s_waitcnt lgkmcnt(2)
    v_mfma_f32_32x32x16_bf16 v[0:15], v[68:71], a[116:119], v[0:15]
    s_waitcnt vmcnt(11)
    v_mfma_f32_32x32x16_bf16 v[16:31], v[68:71], a[124:127], v[16:31]
    ds_read_b64_tr_b16 v[76:77], v91 offset:11264
    ds_read_b64_tr_b16 v[78:79], v91 offset:11520
    s_waitcnt lgkmcnt(2)
    v_mfma_f32_32x32x16_bf16 v[32:47], v[72:75], a[0:3], 0
    s_waitcnt vmcnt(10)
    v_mfma_f32_32x32x16_bf16 v[48:63], v[72:75], a[8:11], 0
    ds_read_b64_tr_b16 v[80:81], v91 offset:12288
    ds_read_b64_tr_b16 v[82:83], v91 offset:12544
    s_nop 1
    v_cvt_pk_f16_f32 v0, v0, v1
    v_cvt_pk_f16_f32 v1, v2, v3
    v_and_or_b32 v0, v0, s89, v116
    v_cvt_pk_f16_f32 v2, v4, v5
    v_and_or_b32 v1, v1, s89, v117
    v_cvt_pk_f16_f32 v3, v6, v7
    v_and_or_b32 v2, v2, s89, v118
    v_cvt_pk_f16_f32 v4, v8, v9
    s_waitcnt lgkmcnt(2)
    v_mfma_f32_32x32x16_bf16 v[32:47], v[76:79], a[16:19], v[32:47]
    s_waitcnt vmcnt(7)
    v_and_or_b32 v3, v3, s89, v119
    v_cvt_pk_f16_f32 v5, v10, v11
    v_and_or_b32 v4, v4, s89, v116
    v_cvt_pk_f16_f32 v6, v12, v13
    v_and_or_b32 v5, v5, s89, v117
    v_cvt_pk_f16_f32 v7, v14, v15
    v_and_or_b32 v6, v6, s89, v118
    v_and_or_b32 v7, v7, s89, v119
    v_mfma_f32_32x32x16_bf16 v[48:63], v[76:79], a[24:27], v[48:63]
    ds_read_b64_tr_b16 v[84:85], v91 offset:13312
    ds_read_b64_tr_b16 v[86:87], v91 offset:13568
    v_cvt_pk_f16_f32 v16, v16, v17
    v_cvt_pk_f16_f32 v17, v18, v19
    v_and_or_b32 v16, v16, s89, v116
    v_cvt_pk_f16_f32 v18, v20, v21
    v_and_or_b32 v17, v17, s89, v117
    v_cvt_pk_f16_f32 v19, v22, v23
    v_and_or_b32 v18, v18, s89, v118
    v_cvt_pk_f16_f32 v20, v24, v25
    s_waitcnt lgkmcnt(2)
    v_mfma_f32_32x32x16_bf16 v[32:47], v[80:83], a[32:35], v[32:47]
    s_waitcnt vmcnt(6)
    v_and_or_b32 v19, v19, s89, v119
    v_cvt_pk_f16_f32 v21, v26, v27
    v_and_or_b32 v20, v20, s89, v116
    v_cvt_pk_f16_f32 v22, v28, v29
    v_and_or_b32 v21, v21, s89, v117
    v_cvt_pk_f16_f32 v23, v30, v31
    v_and_or_b32 v22, v22, s89, v118
    v_and_or_b32 v23, v23, s89, v119
    v_mfma_f32_32x32x16_bf16 v[48:63], v[80:83], a[40:43], v[48:63]
    ds_read_b64_tr_b16 v[64:65], v120 offset:6144
    ds_read_b64_tr_b16 v[66:67], v120 offset:6400
    s_waitcnt lgkmcnt(2)
    v_mfma_f32_32x32x16_bf16 v[32:47], v[84:87], a[48:51], v[32:47]
    s_waitcnt vmcnt(3)
    v_mfma_f32_32x32x16_bf16 v[48:63], v[84:87], a[56:59], v[48:63]
    ds_read_b64_tr_b16 v[68:69], v120 offset:7168
    ds_read_b64_tr_b16 v[70:71], v120 offset:7424
    s_waitcnt lgkmcnt(2)
    v_mfma_f32_32x32x16_bf16 v[32:47], v[64:67], a[64:67], v[32:47]
    s_waitcnt vmcnt(2)
    v_mfma_f32_32x32x16_bf16 v[48:63], v[64:67], a[72:75], v[48:63]
    ds_read_b64_tr_b16 v[72:73], v120 offset:8192
    ds_read_b64_tr_b16 v[74:75], v120 offset:8448
    s_waitcnt lgkmcnt(2)
    v_mfma_f32_32x32x16_bf16 v[32:47], v[68:71], a[80:83], v[32:47]
    s_waitcnt vmcnt(1)
    v_mfma_f32_32x32x16_bf16 v[48:63], v[68:71], a[88:91], v[48:63]
    ds_read_b64_tr_b16 v[76:77], v120 offset:9216
    ds_read_b64_tr_b16 v[78:79], v120 offset:9472
    s_waitcnt vmcnt(0)
    v_cmp_ne_u32 vcc, s10, v94
    s_cbranch_vccnz FC_27
FB_29:
    s_cmp_lg_u32 s88, 32
    s_cbranch_scc1 SC_30
    buffer_store_dwordx4 v[0:3], v124, s[44:47], s87 offen offset:0
    buffer_store_dwordx4 v[4:7], v124, s[44:47], s87 offen offset:128
SB_31:
    s_cmp_lg_u32 s88, 32
    s_cbranch_scc1 SC_32
    buffer_store_dwordx4 v[16:19], v124, s[44:47], s87 offen offset:1024
    buffer_store_dwordx4 v[20:23], v124, s[44:47], s87 offen offset:1152
SB_33:
    v_mov_b32 v95, 8
    ds_write_b32 v121, v95 offset:0
    s_waitcnt lgkmcnt(3)
    v_mfma_f32_32x32x16_bf16 v[32:47], v[72:75], a[96:99], v[32:47]
    v_mfma_f32_32x32x16_bf16 v[48:63], v[72:75], a[104:107], v[48:63]
    s_waitcnt lgkmcnt(1)
    v_mfma_f32_32x32x16_bf16 v[32:47], v[76:79], a[112:115], v[32:47]
    v_mfma_f32_32x32x16_bf16 v[48:63], v[76:79], a[120:123], v[48:63]
    s_nop 7
    s_nop 2
    ds_write_b128 v92, v[32:35] offset:0
    ds_write_b128 v92, v[36:39] offset:1152
    ds_write_b128 v92, v[40:43] offset:2304
    ds_write_b128 v92, v[44:47] offset:3456
    ds_write_b128 v92, v[48:51] offset:4608
    ds_write_b128 v92, v[52:55] offset:5760
    ds_write_b128 v92, v[56:59] offset:6912
    ds_write_b128 v92, v[60:63] offset:8064
    v_mov_b32 v95, 9
    ds_write_b32 v121, v95 offset:0
    s_endpgm
SC_19:
    buffer_store_dwordx4 v[0:3], v124, s[44:47], s85 offen offset:0 sc1
    buffer_store_dwordx4 v[4:7], v124, s[44:47], s85 offen offset:128 sc1
    s_branch SB_20
SC_21:
    buffer_store_dwordx4 v[16:19], v124, s[44:47], s85 offen offset:1024 sc1
    buffer_store_dwordx4 v[20:23], v124, s[44:47], s85 offen offset:1152 sc1
    s_branch SB_22
SC_23:
    buffer_store_dwordx4 v[32:35], v104, s[60:63], s86 offen offset:0 sc1
    buffer_store_dwordx4 v[36:39], v104, s[60:63], s86 offen offset:896 sc1
    s_branch SB_24
SC_25:
    buffer_store_dwordx4 v[48:51], v104, s[60:63], s86 offen offset:0 sc1
    buffer_store_dwordx4 v[52:55], v104, s[60:63], s86 offen offset:896 sc1
    s_branch SB_26
FC_27:
    s_mov_b32 s75, 4096
    FT_28:
    buffer_load_dword v94, v93, s[44:47], s9 offen offset:64 sc1
    s_sub_u32 s75, s75, 1
    s_cmp_eq_u32 s75, 0
    s_waitcnt vmcnt(0)
    s_cbranch_scc1 FB_29
    v_cmp_ne_u32 vcc, s10, v94
    s_cbranch_vccnz FT_28
    s_branch FB_29
SC_30:
    buffer_store_dwordx4 v[0:3], v124, s[44:47], s87 offen offset:0 sc1
    buffer_store_dwordx4 v[4:7], v124, s[44:47], s87 offen offset:128 sc1
    s_branch SB_31
SC_32:
    buffer_store_dwordx4 v[16:19], v124, s[44:47], s87 offen offset:1024 sc1
    buffer_store_dwordx4 v[20:23], v124, s[44:47], s87 offen offset:1152 sc1
    s_branch SB_33
L_PROLE:
    s_cmp_lg_u32 s7, 1
    s_cbranch_scc1 NC_35
    s_getpc_b64 s[76:77]
L_PC:
    v_lshlrev_b32 v2, 7, v0
    s_sub_u32 s76, s76, L_PC-gated_mix__ssm_conv_h3__dense_activation_mish__prompt_kernel
    s_subb_u32 s77, s77, 0
    v_min_u32 v2, L_END-gated_mix__ssm_conv_h3__dense_activation_mish__prompt_kernel, v2
    global_load_dword v7, v2, s[76:77]
NC_35:
    s_lshl3_add_u32 s14, s2, s11
    s_cmp_lg_u32 s14, 16
    s_cbranch_scc1 NOEP_34
    s_memrealtime s[72:73]
    v_mov_b32 v3, 0
    s_waitcnt lgkmcnt(0)
    s_mov_b32 s52, s40
    s_and_b32 s53, s41, 0xffff
    s_mov_b32 s54, 0x100
    s_mov_b32 s55, 0x20000
    s_mul_i32 s72, s72, 0x9e3779b1
    s_lshr_b32 s12, s72, 15
    s_xor_b32 s72, s72, s12
    s_mul_i32 s72, s72, 0x85ebca77
    s_lshr_b32 s12, s72, 13
    s_xor_b32 s72, s72, s12
    s_and_b32 s72, s72, 0xfcfcfcfc
    s_or_b32 s72, s72, 0x01010101
    v_mov_b32 v4, s72
    s_mov_b64 exec, 1
    buffer_store_dword v4, v3, s[52:55], 0 offen offset:224 sc1
    s_mov_b64 exec, -1
NOEP_34:
    s_lshl2_add_u32 s9, s7, s11
    v_lshlrev_b32 v2, 7, v127
    v_and_b32 v4, 3, v127
    v_lshlrev_b32 v4, 2, v4
    s_lshr_b32 s10, s9, 1
    s_mul_i32 s12, s3, 28
    s_add_u32 s10, s10, s12
    s_mul_i32 s10, s10, 49152
    s_and_b32 s12, s9, 1
    s_lshl_b32 s12, s12, 13
    s_add_u32 s10, s10, s12
    s_add_u32 s10, s10, 0x400000
    s_lshl4_add_u32 s76, s3, s9
    s_mul_i32 s77, s76, 12544
    s_mul_i32 s76, s76, 16896
    s_cmp_eq_u32 s3, 7
    s_cselect_b32 s76, 0x7f000000, s76
    v_min_u32 v6, 6144, v2
    s_waitcnt lgkmcnt(0)
    s_mov_b32 s44, s42
    s_and_b32 s45, s43, 0xffff
    s_mov_b32 s46, 0x3000000
    s_mov_b32 s47, 0x20000
    s_mov_b32 s48, s34
    s_and_b32 s49, s35, 0xffff
    s_mov_b32 s50, 0x188000
    s_mov_b32 s51, 0x20000
    s_mov_b32 s56, s38
    s_and_b32 s57, s39, 0xffff
    s_mov_b32 s58, 0x1c0000
    s_mov_b32 s59, 0x20000
    s_add_u32 s60, s42, 0x1100000
    s_addc_u32 s61, s43, 0
    s_and_b32 s61, s61, 0xffff
    s_mov_b32 s62, 0x1c0000
    s_mov_b32 s63, 0x20000
    s_mul_i32 s78, s3, 229376
    s_lshl_b32 s12, s9, 13
    s_add_u32 s78, s78, s12
    s_add_u32 s79, s78, 0x20000
    s_cmp_ge_u32 s9, 12
    s_cselect_b32 s79, 0x7f000000, s79
    s_barrier
    s_add_u32 s12, s77, 0
    buffer_load_dword v3, v6, s[48:51], s12 offen
    s_waitcnt vmcnt(0)
    s_add_u32 s12, s77, 6272
    buffer_load_dword v3, v6, s[48:51], s12 offen
    s_waitcnt vmcnt(0)
    s_add_u32 s12, s10, 0
    buffer_load_dword v3, v2, s[44:47], s12 offen sc1
    s_waitcnt vmcnt(0)
    s_add_u32 s12, s10, 393216
    buffer_load_dword v3, v2, s[44:47], s12 offen sc1
    s_waitcnt vmcnt(0)
    s_add_u32 s12, s10, 786432
    buffer_load_dword v3, v2, s[44:47], s12 offen sc1
    s_waitcnt vmcnt(0)
    s_add_u32 s12, s10, 1179648
    s_cmp_ge_u32 s9, 8
    s_cselect_b32 s12, 0x7f000000, s12
    buffer_load_dword v3, v2, s[44:47], s12 offen sc1
    s_waitcnt vmcnt(0)
    buffer_load_dword v3, v2, s[56:59], s78 offen sc1
    s_waitcnt vmcnt(0)
    buffer_load_dword v3, v2, s[56:59], s79 offen sc1
    s_waitcnt vmcnt(0)
    buffer_load_dword v3, v2, s[60:63], s78 offen sc1
    s_waitcnt vmcnt(0)
    buffer_load_dword v3, v2, s[60:63], s79 offen sc1
    s_waitcnt vmcnt(0)
L_PEND:
    s_endpgm
L_CROLE:
    s_setprio 3
    v_and_b32 v125, 15, v127
    s_sub_u32 s76, s11, 4
    s_lshr_b32 s77, s76, 1
    s_and_b32 s78, s76, 1
    s_lshl_b32 s9, s3, 5
    s_add_u32 s9, s9, s7
    s_lshl1_add_u32 s79, s9, s77
    s_mul_i32 s9, s9, 8448
    v_lshrrev_b32 v100, 3, v127
    v_mul_u32_u24 v100, 896, v100
    v_and_b32 v101, 7, v127
    v_and_b32 v102, 1, v126
    v_xor_b32 v101, v101, v102
    s_lshl_b32 s12, s76, 1
    s_add_u32 s13, s12, 2
    s_and_b32 s13, s13, 6
    v_xor_b32 v102, s12, v101
    v_lshl_add_u32 v102, v102, 4, v100
    v_xor_b32 v103, s13, v101
    v_lshl_add_u32 v103, v103, 4, v100
    s_lshl2_add_u32 s12, s7, s76
    s_mul_i32 s12, s12, 14336
    s_lshl_b32 s13, s3, 7
    s_add_u32 s12, s12, s13
    s_add_u32 s13, s12, 7168
    s_lshl_b32 s14, s76, 11
    v_lshlrev_b32 v122, 4, v127
    v_mov_b32 v124, 0
    v_mov_b32 v121, 1
    v_and_b32 v109, 31, v127
    v_lshlrev_b32 v108, 2, v109
    ds_write_b32 v108, v124 offset:16
    s_mul_i32 s82, s77, 4608
    s_add_u32 s82, s82, 152320
    s_lshl_b32 s15, s76, 2
    v_mov_b32 v120, s15
    s_lshl_b32 s84, s79, 12
    s_lshl_b32 s85, s79, 1
    s_and_b32 s85, s85, -4
    s_getreg_b32 s87, hwreg(HW_REG_XCC_ID, 0, 4)
    s_lshl_b32 s86, s3, 12
    s_add_u32 s86, s86, 0x1000000
    s_lshl_b32 s87, s87, 2
    s_mul_i32 s81, s77, 16640
    s_add_u32 s81, s81, 119040
    v_and_b32 v104, 3, v127
    v_lshlrev_b32 v115, 2, v104
    s_mov_b32 s83, 0xfffefffe
    s_cmp_eq_u32 s3, 7
    s_waitcnt lgkmcnt(0)
    s_cbranch_scc1 L_CX7
    s_mov_b32 s48, s18
    s_and_b32 s49, s19, 0xffff
    s_mov_b32 s50, 0x1c0000
    s_mov_b32 s51, 0x20000
    s_mov_b32 s52, s20
    s_and_b32 s53, s21, 0xffff
    s_mov_b32 s54, 0x1c0000
    s_mov_b32 s55, 0x20000
    s_add_u32 m0, s14, 153344
    s_nop 0
    buffer_load_dwordx4 v102, s[48:51], s12 offen lds
    s_add_u32 m0, s14, 154368
    s_nop 0
    buffer_load_dwordx4 v103, s[48:51], s13 offen lds
    s_add_u32 m0, s14, 127360
    s_nop 0
    buffer_load_dwordx4 v102, s[52:55], s12 offen lds
    s_add_u32 m0, s14, 128384
    s_nop 0
    buffer_load_dwordx4 v103, s[52:55], s13 offen lds
    s_mov_b32 s60, s40
    s_and_b32 s61, s41, 0xffff
    s_mov_b32 s62, 0x100
    s_mov_b32 s63, 0x20000
    s_cmp_lg_u32 s76, 0
    s_cbranch_scc1 NH_36
    s_sub_u32 s13, s12, 7168
    s_cmp_eq_u32 s7, 0
    s_cselect_b32 s13, 0x7f000000, s13
    s_mov_b32 m0, 152320
    s_nop 0
    buffer_load_dwordx4 v102, s[48:51], s13 offen lds
NH_36:
    s_mov_b32 s56, s22
    s_and_b32 s57, s23, 0xffff
    s_mov_b32 s58, 0xe00
    s_mov_b32 s59, 0x20000
    v_lshl_add_u32 v105, v126, 2, v104
    v_lshlrev_b32 v106, 3, v105
    s_lshl_b32 s12, s3, 9
    s_lshl_b32 s13, s76, 7
    s_add_u32 s12, s12, s13
    buffer_load_dwordx2 v[28:29], v106, s[56:59], s12 offen
    s_mov_b32 s44, s42
    s_and_b32 s45, s43, 0xffff
    s_mov_b32 s46, 0x3000000
    s_mov_b32 s47, 0x20000
    s_mov_b32 s68, s38
    s_and_b32 s69, s39, 0xffff
    s_mov_b32 s70, 0x1c0000
    s_mov_b32 s71, 0x20000
    s_load_dwordx2 s[38:39], s[24:25], s84
    s_load_dword s10, s[26:27], s85
    s_barrier
    s_add_u32 s48, s24, s84
    s_addc_u32 s49, s25, 0
    s_and_b32 s49, s49, 0xffff
    s_mov_b32 s50, 0x1000
    s_mov_b32 s51, 0x20000
    v_bfe_u32 v109, v127, 2, 2
    v_lshl_add_u32 v110, v104, 4, v109
    v_lshlrev_b32 v110, 7, v110
    v_and_b32 v111, 1, v126
    v_lshl_add_u32 v110, v111, 3, v110
    v_add_u32 v110, 126848, v110
    v_lshrrev_b32 v111, 1, v126
    s_lshl_b32 s12, s76, 1
    v_add_u32 v111, s12, v111
    v_lshrrev_b32 v112, 1, v109
    v_xor_b32 v111, v111, v112
    v_lshlrev_b32 v112, 1, v104
    v_xor_b32 v113, v111, v112
    v_lshl_add_u32 v107, v113, 4, v110
    v_add_u32 v112, 2, v112
    v_and_b32 v112, 6, v112
    v_xor_b32 v113, v111, v112
    v_lshl_add_u32 v108, v113, 4, v110
    v_sub_u32 v112, 3, v109
    v_lshlrev_b32 v111, 6, v105
    v_lshl_add_u32 v111, v112, 4, v111
    v_lshlrev_b32 v67, 3, v112
    v_lshlrev_b32 v119, 3, v104
    s_add_u32 s80, s9, s14
    s_lshl_b32 s14, s78, 11
    s_add_u32 s15, s14, s81
    v_add_u32 v106, 4, v122
    s_add_u32 m0, s15, 32
    s_nop 0
    buffer_load_dwordx4 v122, s[48:51], s14 offen offset:0 lds
    buffer_load_dwordx4 v122, s[48:51], s14 offen offset:1024 lds
    s_add_u32 m0, s15, 4192
    s_nop 0
    buffer_load_dwordx4 v106, s[48:51], s14 offen offset:0 lds
    buffer_load_dwordx4 v106, s[48:51], s14 offen offset:1024 lds
    s_load_dword s72, s[40:41], 224
    s_waitcnt vmcnt(4)
    v_mov_b32 v123, 1
    ds_write_b32 v120, v123 offset:32
    s_mov_b32 s75, 65536
LS_37:
    ds_read_b32 v114, v115 offset:32
    s_sub_u32 s75, s75, 1
    s_cmp_eq_u32 s75, 0
    s_cbranch_scc1 LD_38
    s_waitcnt lgkmcnt(0)
    v_cmp_gt_u32 vcc, 1, v114
    s_cbranch_vccnz LS_37
LD_38:
    s_waitcnt lgkmcnt(0)
    ds_read_b64_tr_b16 v[0:1], v107 offset:25984
    ds_read_b64_tr_b16 v[2:3], v107 offset:26496
    ds_read_b64_tr_b16 v[4:5], v107 offset:27008
    ds_read_b64_tr_b16 v[6:7], v108 offset:27520
    ds_read_b64_tr_b16 v[8:9], v108 offset:28032
    ds_read_b64_tr_b16 v[20:21], v107 offset:512
    ds_read_b64_tr_b16 v[22:23], v107 offset:1024
    ds_read_b64_tr_b16 v[24:25], v108 offset:1536
    ds_read_b64_tr_b16 v[26:27], v108 offset:2048
    v_alignbit_b32 v30, v28, v28, 16
    v_alignbit_b32 v31, v29, v29, 16
    s_waitcnt lgkmcnt(4)
    v_alignbit_b32 v11, v1, v0, 16
    v_alignbit_b32 v12, v2, v1, 16
    v_alignbit_b32 v13, v3, v2, 16
    v_alignbit_b32 v14, v4, v3, 16
    v_alignbit_b32 v15, v5, v4, 16
    v_alignbit_b32 v16, v6, v5, 16
    v_alignbit_b32 v17, v7, v6, 16
    v_alignbit_b32 v18, v8, v7, 16
    v_alignbit_b32 v19, v9, v8, 16
    v_dot2_f32_bf16 v32, v11, v31, 0
    v_dot2_f32_bf16 v33, v1, v31, 0
    v_dot2_f32_bf16 v34, v12, v31, 0
    v_dot2_f32_bf16 v35, v2, v31, 0
    v_dot2_f32_bf16 v36, v13, v31, 0
    v_dot2_f32_bf16 v37, v3, v31, 0
    v_dot2_f32_bf16 v38, v14, v31, 0
    v_dot2_f32_bf16 v39, v4, v31, 0
    v_dot2_f32_bf16 v40, v15, v31, 0
    v_dot2_f32_bf16 v41, v5, v31, 0
    v_dot2_f32_bf16 v42, v16, v31, 0
    v_dot2_f32_bf16 v43, v6, v31, 0
    v_dot2_f32_bf16 v44, v17, v31, 0
    v_dot2_f32_bf16 v45, v7, v31, 0
    v_dot2_f32_bf16 v46, v18, v31, 0
    v_dot2_f32_bf16 v47, v8, v31, 0
    v_dot2_f32_bf16 v32, v12, v30, v32
    v_dot2_f32_bf16 v33, v2, v30, v33
    v_dot2_f32_bf16 v34, v13, v30, v34
    v_dot2_f32_bf16 v35, v3, v30, v35
    v_dot2_f32_bf16 v36, v14, v30, v36
    v_dot2_f32_bf16 v37, v4, v30, v37
    v_dot2_f32_bf16 v38, v15, v30, v38
    v_dot2_f32_bf16 v39, v5, v30, v39
    v_dot2_f32_bf16 v40, v16, v30, v40
    v_dot2_f32_bf16 v41, v6, v30, v41
    v_dot2_f32_bf16 v42, v17, v30, v42
    v_dot2_f32_bf16 v43, v7, v30, v43
    v_dot2_f32_bf16 v44, v18, v30, v44
    v_dot2_f32_bf16 v45, v8, v30, v45
    v_dot2_f32_bf16 v46, v19, v30, v46
    v_dot2_f32_bf16 v47, v9, v30, v47
    s_waitcnt lgkmcnt(0)
    ds_write_b32 v120, v121 offset:16
    v_lshlrev_b32 v48, 16, v20
    v_and_b32 v49, 0xffff0000, v20
    v_lshlrev_b32 v50, 16, v21
    v_and_b32 v51, 0xffff0000, v21
    v_lshlrev_b32 v52, 16, v22
    v_and_b32 v53, 0xffff0000, v22
    v_lshlrev_b32 v54, 16, v23
    v_and_b32 v55, 0xffff0000, v23
    v_lshlrev_b32 v56, 16, v24
    v_and_b32 v57, 0xffff0000, v24
    v_lshlrev_b32 v58, 16, v25
    v_and_b32 v59, 0xffff0000, v25
    v_lshlrev_b32 v60, 16, v26
    v_and_b32 v61, 0xffff0000, v26
    v_lshlrev_b32 v62, 16, v27
    v_and_b32 v63, 0xffff0000, v27
    v_mul_f32 v32, v32, v48
    v_mul_f32 v33, v33, v49
    v_mul_f32 v34, v34, v50
    v_mul_f32 v35, v35, v51
    v_mul_f32 v36, v36, v52
    v_mul_f32 v37, v37, v53
    v_mul_f32 v38, v38, v54
    v_mul_f32 v39, v39, v55
    v_mul_f32 v40, v40, v56
    v_mul_f32 v41, v41, v57
    v_mul_f32 v42, v42, v58
    v_mul_f32 v43, v43, v59
    v_mul_f32 v44, v44, v60
    v_mul_f32 v45, v45, v61
    v_mul_f32 v46, v46, v62
    v_mul_f32 v47, v47, v63
    v_cvt_pk_bf16_f32 v0, v47, v46
    v_cvt_pk_bf16_f32 v1, v45, v44
    v_cvt_pk_bf16_f32 v2, v43, v42
    v_cvt_pk_bf16_f32 v3, v41, v40
    v_cvt_pk_bf16_f32 v4, v39, v38
    v_cvt_pk_bf16_f32 v5, v37, v36
    v_cvt_pk_bf16_f32 v6, v35, v34
    v_cvt_pk_bf16_f32 v7, v33, v32
    s_cmp_lg_u32 s72, 0
    s_cbranch_scc1 ED_40
    s_mov_b32 s75, 4096
EP_39:
    buffer_load_dword v98, v124, s[60:63], 0 offen offset:224 sc1
    s_waitcnt vmcnt(0)
    v_readfirstlane_b32 s72, v98
    s_sub_u32 s75, s75, 1
    s_cmp_eq_u32 s75, 0
    s_cbranch_scc1 ED_40
    s_cmp_lg_u32 s72, 0
    s_cbranch_scc0 EP_39
ED_40:
    s_nop 0
    v_bfe_u32 v67, s72, v67, 8
    v_lshl_or_b32 v67, v67, 15, v67
    v_and_b32 v64, 0x10001, v67
    v_lshrrev_b32 v65, 2, v67
    v_lshrrev_b32 v66, 4, v67
    v_lshrrev_b32 v67, 6, v67
    v_and_b32 v65, 0x10001, v65
    v_and_b32 v66, 0x10001, v66
    v_and_b32 v67, 0x10001, v67
    v_and_or_b32 v0, v0, s83, v64
    v_and_or_b32 v1, v1, s83, v65
    v_and_or_b32 v2, v2, s83, v66
    v_and_or_b32 v3, v3, s83, v67
    v_and_or_b32 v4, v4, s83, v64
    v_and_or_b32 v5, v5, s83, v65
    v_and_or_b32 v6, v6, s83, v66
    v_and_or_b32 v7, v7, s83, v67
    buffer_store_dwordx4 v[0:3], v111, s[44:47], s80 offen offset:0
    buffer_store_dwordx4 v[4:7], v111, s[44:47], s80 offen offset:1024
    v_mov_b32 v98, v111
    s_waitcnt vmcnt(2)
    v_mov_b32 v123, 2
    ds_write_b32 v120, v123 offset:32
    s_xor_b32 s87, s87, s72
    s_cmp_lg_u32 s76, 0
    s_cbranch_scc1 NR_41
    v_mov_b32 v64, s72
    ds_write_b32 v124, v64 offset:68
    s_lshl_b32 s12, s7, 7
    s_add_u32 s12, s12, s86
    v_mov_b32 v64, s87
    s_mov_b64 exec, 0xff
    buffer_store_dwordx4 v[64:67], v122, s[44:47], s12 offen
    s_mov_b64 exec, -1
NR_41:
    v_bfe_u32 v119, s72, v119, 8
    v_lshl_or_b32 v119, v119, 15, v119
    v_and_b32 v116, 0x10001, v119
    v_lshrrev_b32 v117, 2, v119
    v_lshrrev_b32 v118, 4, v119
    v_lshrrev_b32 v119, 6, v119
    v_and_b32 v117, 0x10001, v117
    v_and_b32 v118, 0x10001, v118
    v_and_b32 v119, 0x10001, v119
    v_lshrrev_b32 v102, 3, v127
    v_mul_u32_u24 v100, 8448, v102
    v_and_b32 v103, 0x70, v122
    v_add_u32 v100, v100, v103
    s_lshl2_add_u32 s84, s3, s76
    s_mul_i32 s84, s84, 67584
    s_lshr_b32 s12, s7, 3
    s_lshl_b32 s12, s12, 11
    s_and_b32 s13, s7, 7
    s_lshl_b32 s13, s13, 7
    s_add_u32 s84, s84, s12
    s_add_u32 s84, s84, s13
    v_bfe_u32 v103, v127, 2, 1
    v_mul_u32_u24 v101, 4608, v103
    v_lshl_add_u32 v101, v104, 5, v101
    v_lshlrev_b32 v102, 7, v102
    v_sub_u32 v101, v101, v102
    s_lshl_b32 s12, s76, 10
    s_sub_u32 s12, 156288, s12
    v_add_u32 v101, s12, v101
    v_add_u32 v106, s15, v122
    v_bfe_u32 v108, v127, 3, 2
    v_mul_u32_u24 v108, 4128, v108
    v_lshl_add_u32 v108, v127, 2, v108
    v_add_u32 v108, s81, v108
    v_mov_b32 v16, 0
    s_lshl_b32 s12, s38, 16
    s_lshr_b32 s13, s38, 16
    s_pack_ll_b32_b16 s13, s13, s39
    v_writelane_b32 v16, s38, 15
    v_writelane_b32 v16, s12, 23
    v_writelane_b32 v16, s12, 30
    v_writelane_b32 v16, s13, 31
    s_lshl_b32 s12, s78, 8
    s_add_u32 s12, s12, s82
    v_lshl_add_u32 v109, v127, 2, s12
    s_mov_b32 s75, 65536
LS_42:
    ds_read_b32 v114, v115 offset:32
    s_sub_u32 s75, s75, 1
    s_cmp_eq_u32 s75, 0
    s_cbranch_scc1 LD_43
    s_waitcnt lgkmcnt(0)
    v_cmp_gt_u32 vcc, 2, v114
    s_cbranch_vccnz LS_42
LD_43:
    s_waitcnt lgkmcnt(0)
    ds_read_b128 v[40:43], v106 offset:32
    ds_read_b64 v[44:45], v106 offset:48
    ds_read_b128 v[46:49], v106 offset:1056
    ds_read_b64 v[50:51], v106 offset:1072
    s_mov_b64 exec, 0xffffffff
    ds_write_b32 v108, v16
    s_mov_b64 exec, -1
    ds_write_b32 v109, v124 offset:4096
    s_waitcnt lgkmcnt(4)
    v_alignbit_b32 v52, v41, v40, 16
    v_alignbit_b32 v53, v42, v41, 16
    v_alignbit_b32 v54, v43, v42, 16
    v_alignbit_b32 v55, v44, v43, 16
    ds_write_b128 v106, v[52:55] offset:8352
    v_alignbit_b32 v56, v42, v41, 16
    v_alignbit_b32 v57, v43, v42, 16
    v_alignbit_b32 v58, v44, v43, 16
    v_alignbit_b32 v59, v45, v44, 16
    ds_write_b128 v106, v[56:59] offset:12512
    s_waitcnt lgkmcnt(4)
    v_alignbit_b32 v60, v47, v46, 16
    v_alignbit_b32 v61, v48, v47, 16
    v_alignbit_b32 v62, v49, v48, 16
    v_alignbit_b32 v63, v50, v49, 16
    ds_write_b128 v106, v[60:63] offset:9376
    v_alignbit_b32 v64, v48, v47, 16
    v_alignbit_b32 v65, v49, v48, 16
    v_alignbit_b32 v66, v50, v49, 16
    v_alignbit_b32 v67, v51, v50, 16
    ds_write_b128 v106, v[64:67] offset:13536
    buffer_load_dwordx4 v[32:35], v100, s[44:47], s84 offen offset:0 sc1
    buffer_load_dwordx4 v[36:39], v100, s[44:47], s84 offen offset:1024 sc1
    s_cmp_lt_u32 s7, 4
    s_cbranch_scc1 L_CCONV
L_CGATE:
    v_mov_b32 v113, 161536
    v_lshrrev_b32 v108, 5, v127
    v_lshl_add_u32 v105, v108, 4, v104
    v_mul_u32_u24 v108, 160, v108
    v_add_u32 v108, v108, v115
    v_bfe_u32 v106, v127, 2, 3
    v_lshlrev_b32 v103, 4, v106
    v_lshrrev_b32 v107, 1, v104
    s_lshl_b32 s12, s76, 1
    v_add_u32 v107, s12, v107
    v_xor_b32 v109, v107, v106
    v_lshlrev_b32 v102, 7, v105
    v_lshl_add_u32 v102, v109, 4, v102
    s_lshl_b32 s12, s76, 9
    s_add_u32 s12, s12, 256
    s_lshl_b32 s13, s5, 13
    s_add_u32 s13, s13, s12
    v_add_u32 v102, s13, v102
    v_bfe_u32 v109, v127, 1, 3
    v_and_b32 v109, 6, v109
    v_xor_b32 v109, v109, v126
    v_lshl_add_u32 v112, v109, 4, v113
    v_xor_b32 v113, 64, v112
    v_xor_b32 v109, v109, v107
    v_lshl_add_u32 v110, v109, 4, s12
    v_lshl_add_u32 v110, v104, 7, v110
    v_and_b32 v109, 4, v127
    v_lshl_add_u32 v110, v109, 10, v110
    v_and_b32 v109, 8, v127
    v_lshl_add_u32 v110, v109, 8, v110
    v_xor_b32 v111, 64, v110
    v_mov_b32 v109, 0x7fffffff
    s_mov_b32 s75, 65536
LS_44:
    s_sleep 1
    ds_read_b32 v114, v115 offset:0
    s_sub_u32 s75, s75, 1
    s_cmp_eq_u32 s75, 0
    s_cbranch_scc1 LD_45
    s_waitcnt lgkmcnt(0)
    v_cmp_gt_u32 vcc, 1, v114
    s_cbranch_vccnz LS_44
LD_45:
    s_waitcnt lgkmcnt(0)
    ds_read_b128 a[0:3], v112 offset:0
    ds_read_b128 a[4:7], v110 offset:0
    ds_read_b128 a[8:11], v113 offset:0
    ds_read_b128 a[12:15], v111 offset:0
    ds_read_b128 a[16:19], v112 offset:128
    ds_read_b128 a[20:23], v110 offset:8192
    ds_read_b128 a[24:27], v113 offset:128
    ds_read_b128 a[28:31], v111 offset:8192
    ds_read_b128 a[32:35], v112 offset:256
    ds_read_b128 a[36:39], v110 offset:16384
    ds_read_b128 a[40:43], v113 offset:256
    ds_read_b128 a[44:47], v111 offset:16384
    ds_read_b128 a[48:51], v112 offset:384
    ds_read_b128 a[52:55], v110 offset:24576
    s_waitcnt lgkmcnt(12)
    v_mfma_f32_16x16x32_bf16 v[0:3], a[0:3], a[4:7], 0
    ds_read_b128 a[56:59], v113 offset:384
    ds_read_b128 a[60:63], v111 offset:24576
    s_waitcnt lgkmcnt(12)
    v_mfma_f32_16x16x32_bf16 v[4:7], a[8:11], a[12:15], 0
    ds_read_b128 a[64:67], v112 offset:512
    ds_read_b128 a[68:71], v110 offset:32768
    s_waitcnt lgkmcnt(12)
    v_mfma_f32_16x16x32_bf16 v[0:3], a[16:19], a[20:23], v[0:3]
    ds_read_b128 a[72:75], v113 offset:512
    ds_read_b128 a[76:79], v111 offset:32768
    s_waitcnt lgkmcnt(12)
    v_mfma_f32_16x16x32_bf16 v[4:7], a[24:27], a[28:31], v[4:7]
    ds_read_b128 a[80:83], v112 offset:640
    ds_read_b128 a[84:87], v110 offset:40960
    s_waitcnt lgkmcnt(12)
    v_mfma_f32_16x16x32_bf16 v[0:3], a[32:35], a[36:39], v[0:3]
    ds_read_b128 a[88:91], v113 offset:640
    ds_read_b128 a[92:95], v111 offset:40960
    s_waitcnt lgkmcnt(12)
    v_mfma_f32_16x16x32_bf16 v[4:7], a[40:43], a[44:47], v[4:7]
    ds_read_b128 a[96:99], v112 offset:768
    ds_read_b128 a[100:103], v110 offset:49152
    s_waitcnt lgkmcnt(12)
    v_mfma_f32_16x16x32_bf16 v[0:3], a[48:51], a[52:55], v[0:3]
    ds_read_b128 a[104:107], v113 offset:768
    ds_read_b128 a[108:111], v111 offset:49152
    s_waitcnt lgkmcnt(12)
    v_mfma_f32_16x16x32_bf16 v[4:7], a[56:59], a[60:63], v[4:7]
    ds_read_b128 v[68:71], v102 offset:0
    ds_read_b128 v[72:75], v102 offset:4096
    ds_write_b32 v120, v109 offset:16
    s_waitcnt lgkmcnt(13)
    v_mfma_f32_16x16x32_bf16 v[0:3], a[64:67], a[68:71], v[0:3]
    s_waitcnt lgkmcnt(11)
    v_mfma_f32_16x16x32_bf16 v[4:7], a[72:75], a[76:79], v[4:7]
    s_waitcnt lgkmcnt(9)
    v_mfma_f32_16x16x32_bf16 v[0:3], a[80:83], a[84:87], v[0:3]
    s_waitcnt lgkmcnt(7)
    v_mfma_f32_16x16x32_bf16 v[4:7], a[88:91], a[92:95], v[4:7]
    s_waitcnt lgkmcnt(5)
    v_mfma_f32_16x16x32_bf16 v[0:3], a[96:99], a[100:103], v[0:3]
    s_waitcnt lgkmcnt(3)
    v_mfma_f32_16x16x32_bf16 v[4:7], a[104:107], a[108:111], v[4:7]
    s_waitcnt lgkmcnt(1)
    v_lshlrev_b32 v80, 16, v68
    v_and_b32 v81, 0xffff0000, v68
    v_lshlrev_b32 v82, 16, v69
    v_and_b32 v83, 0xffff0000, v69
    v_lshlrev_b32 v84, 16, v70
    v_and_b32 v85, 0xffff0000, v70
    v_lshlrev_b32 v86, 16, v71
    v_and_b32 v87, 0xffff0000, v71
    v_add_f32 v0, v0, v4
    v_lshlrev_b32 v88, 16, v72
    v_cvt_pk_bf16_f32 v0, v0, 0
    v_and_b32 v89, 0xffff0000, v72
    v_lshlrev_b32 v0, 16, v0
    v_lshlrev_b32 v90, 16, v73
    v_mul_f32 v0, 0xbfb8aa3b, v0
    v_and_b32 v91, 0xffff0000, v73
    v_exp_f32 v0, v0
    v_lshlrev_b32 v92, 16, v74
    v_add_f32 v0, 1.0, v0
    v_and_b32 v93, 0xffff0000, v74
    v_rcp_f32 v0, v0
    v_lshlrev_b32 v94, 16, v75
    v_cvt_pk_bf16_f32 v0, v0, 0
    v_and_b32 v95, 0xffff0000, v75
    v_lshlrev_b32 v0, 16, v0
    ds_bpermute_b32 v2, v108, v0 offset:0
    ds_bpermute_b32 v3, v108, v0 offset:80
    v_mul_u32_u24 v113, 896, v105
    v_add_u32 v113, v113, v103
    s_lshl_b32 s12, s4, 4
    s_add_u32 s12, s12, s76
    s_mul_i32 s12, s12, 3584
    s_lshl_b32 s13, s5, 7
    s_add_u32 s90, s12, s13
    s_add_u32 s91, s90, 28672
    s_waitcnt lgkmcnt(0)
    v_sub_f32 v96, 1.0, v2
    v_sub_f32 v97, 1.0, v3
    v_cvt_pk_bf16_f32 v96, v96, 0
    v_cvt_pk_bf16_f32 v97, v97, 0
    v_lshlrev_b32 v96, 16, v96
    v_lshlrev_b32 v97, 16, v97
    v_mul_f32 v80, v80, v2
    v_mul_f32 v81, v81, v2
    v_mul_f32 v82, v82, v2
    v_mul_f32 v83, v83, v2
    v_mul_f32 v84, v84, v2
    v_mul_f32 v85, v85, v2
    v_mul_f32 v86, v86, v2
    v_mul_f32 v87, v87, v2
    v_mul_f32 v88, v88, v3
    v_mul_f32 v89, v89, v3
    v_mul_f32 v90, v90, v3
    v_mul_f32 v91, v91, v3
    v_mul_f32 v92, v92, v3
    v_mul_f32 v93, v93, v3
    v_mul_f32 v94, v94, v3
    v_mul_f32 v95, v95, v3
    s_cmp_eq_u32 s3, 7
    s_cbranch_scc1 L_CFIN
L_CCONV:
    v_add_u32 v109, 1, v125
    v_and_b32 v108, 1, v109
    v_bfe_u32 v107, v109, 1, 1
    v_lshl_add_u32 v108, v108, 1, v107
    v_mul_u32_u24 v108, 4160, v108
    v_lshrrev_b32 v109, 2, v109
    v_add_u32 v109, 6, v109
    v_lshlrev_b32 v107, 1, v126
    v_sub_u32 v109, v109, v107
    v_lshl_add_u32 v109, v109, 3, v108
    v_add_u32 v110, s81, v109
    v_lshl_add_u32 v109, v125, 1, v126
    v_sub_u32 v109, 33, v109
    v_lshl_add_u32 v111, v109, 4, s82
    s_lshl_b32 s12, s77, 4
    s_lshr_b32 s10, s10, s12
    s_lshl_b32 s10, s10, 16
    v_lshlrev_b32 v109, 5, v125
    v_lshl_add_u32 v109, v126, 3, v109
    s_add_u32 s12, s82, 504
    v_sub_u32 v108, s12, v109
    v_and_b32 v99, 31, v127
    v_lshlrev_b32 v99, 7, v99
    s_mov_b32 s75, 4096
    s_waitcnt vmcnt(0)
    s_branch TM_47
TT_46:
    s_cmp_eq_u32 s75, 4088
    s_cbranch_scc1 KF_49
KB_50:
    s_sleep 4
    buffer_load_dwordx4 v[32:35], v100, s[44:47], s84 offen offset:0 sc1
    buffer_load_dwordx4 v[36:39], v100, s[44:47], s84 offen offset:1024 sc1
    s_sub_u32 s75, s75, 1
    s_cmp_eq_u32 s75, 0
    s_waitcnt vmcnt(0)
    s_cbranch_scc1 TD_48
TM_47:
    v_xor_b32 v0, v32, v116
    v_xor_b32 v1, v33, v117
    v_bitop3_b32 v0, v34, v118, v0 bitop3:0xbe
    v_bitop3_b32 v1, v35, v119, v1 bitop3:0xbe
    v_bitop3_b32 v0, v36, v116, v0 bitop3:0xbe
    v_bitop3_b32 v1, v37, v117, v1 bitop3:0xbe
    v_bitop3_b32 v0, v38, v118, v0 bitop3:0xbe
    v_bitop3_b32 v1, v39, v119, v1 bitop3:0xbe
    v_or_b32 v0, v0, v1
    v_and_b32 v0, 0x10001, v0
    v_cmp_ne_u32 vcc, 0, v0
    s_cbranch_vccnz TT_46
TD_48:
    buffer_load_dword v99, v99, s[44:47], s86 offen sc1
    ds_write_b128 v101, v[32:35] offset:0
    ds_write_b128 v101, v[36:39] offset:16
    v_mov_b32 v123, 3
    ds_write_b32 v120, v123 offset:32
    s_mov_b32 s75, 65536
LS_51:
    ds_read_b32 v114, v115 offset:32
    s_sub_u32 s75, s75, 1
    s_cmp_eq_u32 s75, 0
    s_cbranch_scc1 LD_52
    s_waitcnt lgkmcnt(0)
    v_cmp_gt_u32 vcc, 3, v114
    s_cbranch_vccnz LS_51
LD_52:
    s_waitcnt lgkmcnt(0)
    s_setprio 0
    s_cmp_lg_u32 s78, 0
    s_cbranch_scc1 CV_53
    ds_read_b64 a[0:1], v110 offset:0
    ds_read_b64 a[2:3], v110 offset:8
    ds_read_b128 a[32:35], v111 offset:3584
    ds_read_b64 a[4:5], v110 offset:512
    ds_read_b64 a[6:7], v110 offset:520
    ds_read_b128 a[36:39], v111 offset:3072
    ds_read_b64 a[8:9], v110 offset:1024
    ds_read_b64 a[10:11], v110 offset:1032
    ds_read_b128 a[40:43], v111 offset:2560
    ds_read_b64 a[12:13], v110 offset:1536
    ds_read_b64 a[14:15], v110 offset:1544
    ds_read_b128 a[44:47], v111 offset:2048
    ds_read_b64 a[16:17], v110 offset:2048
    ds_read_b64 a[18:19], v110 offset:2056
    ds_read_b128 a[48:51], v111 offset:1536
    ds_read_b64 a[20:21], v110 offset:2560
    ds_read_b64 a[22:23], v110 offset:2568
    ds_read_b128 a[52:55], v111 offset:1024
    ds_read_b64 a[24:25], v110 offset:3072
    ds_read_b64 a[26:27], v110 offset:3080
    ds_read_b128 a[56:59], v111 offset:512
    ds_read_b64 a[28:29], v110 offset:3584
    ds_read_b64 a[30:31], v110 offset:3592
    ds_read_b128 a[60:63], v111 offset:0
    ds_read_b64 v[48:49], v108 offset:3584
    ds_read_b64 v[50:51], v108 offset:3072
    ds_read_b64 v[52:53], v108 offset:512
    ds_read_b64 v[54:55], v108 offset:0
    s_waitcnt lgkmcnt(0)
    v_mfma_f32_16x16x32_bf16 v[8:11], a[0:3], a[56:59], 0
    ds_read_b64 a[64:65], v110 offset:64
    ds_read_b64 a[66:67], v110 offset:72
    v_mfma_f32_16x16x32_bf16 v[12:15], a[0:3], a[60:63], 0
    ds_read_b128 a[96:99], v111 offset:3648
    ds_read_b64 a[68:69], v110 offset:576
    v_mfma_f32_16x16x32_bf16 v[0:3], a[0:3], a[32:35], 0
    ds_read_b64 a[70:71], v110 offset:584
    ds_read_b128 a[100:103], v111 offset:3136
    v_mfma_f32_16x16x32_bf16 v[8:11], a[4:7], a[52:55], v[8:11]
    ds_read_b64 a[72:73], v110 offset:1088
    ds_read_b64 a[74:75], v110 offset:1096
    v_mfma_f32_16x16x32_bf16 v[12:15], a[4:7], a[56:59], v[12:15]
    ds_read_b128 a[104:107], v111 offset:2624
    ds_read_b64 a[76:77], v110 offset:1600
    v_mfma_f32_16x16x32_bf16 v[4:7], a[0:3], a[36:39], 0
    ds_read_b64 a[78:79], v110 offset:1608
    ds_read_b128 a[108:111], v111 offset:2112
    v_mfma_f32_16x16x32_bf16 v[8:11], a[8:11], a[48:51], v[8:11]
    ds_read_b64 a[80:81], v110 offset:2112
    ds_read_b64 a[82:83], v110 offset:2120
    v_mfma_f32_16x16x32_bf16 v[12:15], a[8:11], a[52:55], v[12:15]
    ds_read_b128 a[112:115], v111 offset:1600
    ds_read_b64 a[84:85], v110 offset:2624
    v_mfma_f32_16x16x32_bf16 v[4:7], a[4:7], a[32:35], v[4:7]
    ds_read_b64 a[86:87], v110 offset:2632
    ds_read_b128 a[116:119], v111 offset:1088
    v_mfma_f32_16x16x32_bf16 v[8:11], a[12:15], a[44:47], v[8:11]
    ds_read_b64 a[88:89], v110 offset:3136
    ds_read_b64 a[90:91], v110 offset:3144
    v_mfma_f32_16x16x32_bf16 v[12:15], a[12:15], a[48:51], v[12:15]
    ds_read_b128 a[120:123], v111 offset:576
    ds_read_b64 a[92:93], v110 offset:3648
    v_mfma_f32_16x16x32_bf16 v[8:11], a[16:19], a[40:43], v[8:11]
    ds_read_b64 a[94:95], v110 offset:3656
    ds_read_b128 a[124:127], v111 offset:64
    v_mfma_f32_16x16x32_bf16 v[12:15], a[16:19], a[44:47], v[12:15]
    v_and_b32 v56, 0xffff0000, v49
    v_lshlrev_b32 v57, 16, v49
    v_mfma_f32_16x16x32_bf16 v[8:11], a[20:23], a[36:39], v[8:11]
    v_and_b32 v58, 0xffff0000, v48
    v_lshlrev_b32 v59, 16, v48
    v_mfma_f32_16x16x32_bf16 v[12:15], a[20:23], a[40:43], v[12:15]
    v_and_b32 v60, 0xffff0000, v51
    v_lshlrev_b32 v61, 16, v51
    v_mfma_f32_16x16x32_bf16 v[8:11], a[24:27], a[32:35], v[8:11]
    v_and_b32 v62, 0xffff0000, v50
    v_lshlrev_b32 v63, 16, v50
    v_mfma_f32_16x16x32_bf16 v[12:15], a[24:27], a[36:39], v[12:15]
    v_and_b32 v64, 0xffff0000, v53
    v_lshlrev_b32 v65, 16, v53
    v_mfma_f32_16x16x32_bf16 v[12:15], a[28:31], a[32:35], v[12:15]
    v_and_b32 v66, 0xffff0000, v52
    v_lshlrev_b32 v67, 16, v52
    s_waitcnt lgkmcnt(0)
    v_mfma_f32_16x16x32_bf16 v[8:11], a[64:67], a[120:123], v[8:11]
    ds_read_b64 a[0:1], v110 offset:128
    ds_read_b64 a[2:3], v110 offset:136
    v_mfma_f32_16x16x32_bf16 v[12:15], a[64:67], a[124:127], v[12:15]
    ds_read_b128 a[32:35], v111 offset:3712
    ds_read_b64 a[4:5], v110 offset:640
    v_mfma_f32_16x16x32_bf16 v[0:3], a[64:67], a[96:99], v[0:3]
    ds_read_b64 a[6:7], v110 offset:648
    ds_read_b128 a[36:39], v111 offset:3200
    v_mfma_f32_16x16x32_bf16 v[8:11], a[68:71], a[116:119], v[8:11]
    ds_read_b64 a[8:9], v110 offset:1152
    ds_read_b64 a[10:11], v110 offset:1160
    v_mfma_f32_16x16x32_bf16 v[12:15], a[68:71], a[120:123], v[12:15]
    ds_read_b128 a[40:43], v111 offset:2688
    ds_read_b64 a[12:13], v110 offset:1664
    v_mfma_f32_16x16x32_bf16 v[4:7], a[64:67], a[100:103], v[4:7]
    ds_read_b64 a[14:15], v110 offset:1672
    ds_read_b128 a[44:47], v111 offset:2176
    v_mfma_f32_16x16x32_bf16 v[8:11], a[72:75], a[112:115], v[8:11]
    ds_read_b64 a[16:17], v110 offset:2176
    ds_read_b64 a[18:19], v110 offset:2184
    v_mfma_f32_16x16x32_bf16 v[12:15], a[72:75], a[116:119], v[12:15]
    ds_read_b128 a[48:51], v111 offset:1664
    ds_read_b64 a[20:21], v110 offset:2688
    v_mfma_f32_16x16x32_bf16 v[4:7], a[68:71], a[96:99], v[4:7]
    ds_read_b64 a[22:23], v110 offset:2696
    ds_read_b128 a[52:55], v111 offset:1152
    v_mfma_f32_16x16x32_bf16 v[8:11], a[76:79], a[108:111], v[8:11]
    ds_read_b64 a[24:25], v110 offset:3200
    ds_read_b64 a[26:27], v110 offset:3208
    v_mfma_f32_16x16x32_bf16 v[12:15], a[76:79], a[112:115], v[12:15]
    ds_read_b128 a[56:59], v111 offset:640
    ds_read_b64 a[28:29], v110 offset:3712
    v_mfma_f32_16x16x32_bf16 v[8:11], a[80:83], a[104:107], v[8:11]
    ds_read_b64 a[30:31], v110 offset:3720
    ds_read_b128 a[60:63], v111 offset:128
    v_mfma_f32_16x16x32_bf16 v[12:15], a[80:83], a[108:111], v[12:15]
    v_and_b32 v68, 0xffff0000, v55
    v_lshlrev_b32 v69, 16, v55
    v_mfma_f32_16x16x32_bf16 v[8:11], a[84:87], a[100:103], v[8:11]
    v_and_b32 v70, 0xffff0000, v54
    v_lshlrev_b32 v71, 16, v54
    v_mfma_f32_16x16x32_bf16 v[12:15], a[84:87], a[104:107], v[12:15]
    v_bfe_u32 v101, v127, 2, 3
    v_lshlrev_b32 v100, 8, v101
    v_mfma_f32_16x16x32_bf16 v[8:11], a[88:91], a[96:99], v[8:11]
    v_lshl_add_u32 v100, v104, 4, v100
    v_lshrrev_b32 v101, 5, v127
    v_mfma_f32_16x16x32_bf16 v[12:15], a[88:91], a[100:103], v[12:15]
    v_lshl_add_u32 v100, v101, 6, v100
    v_lshrrev_b32 v75, 1, v100
    v_mfma_f32_16x16x32_bf16 v[12:15], a[92:95], a[96:99], v[12:15]
    v_and_b32 v75, 24, v75
    v_bfe_u32 v75, s72, v75, 8
    s_waitcnt lgkmcnt(0)
    v_mfma_f32_16x16x32_bf16 v[8:11], a[0:3], a[56:59], v[8:11]
    ds_read_b64 a[64:65], v110 offset:192
    ds_read_b64 a[66:67], v110 offset:200
    v_mfma_f32_16x16x32_bf16 v[12:15], a[0:3], a[60:63], v[12:15]
    ds_read_b128 a[96:99], v111 offset:3776
    ds_read_b64 a[68:69], v110 offset:704
    v_mfma_f32_16x16x32_bf16 v[0:3], a[0:3], a[32:35], v[0:3]
    ds_read_b64 a[70:71], v110 offset:712
    ds_read_b128 a[100:103], v111 offset:3264
    v_mfma_f32_16x16x32_bf16 v[8:11], a[4:7], a[52:55], v[8:11]
    ds_read_b64 a[72:73], v110 offset:1216
    ds_read_b64 a[74:75], v110 offset:1224
    v_mfma_f32_16x16x32_bf16 v[12:15], a[4:7], a[56:59], v[12:15]
    ds_read_b128 a[104:107], v111 offset:2752
    ds_read_b64 a[76:77], v110 offset:1728
    v_mfma_f32_16x16x32_bf16 v[4:7], a[0:3], a[36:39], v[4:7]
    ds_read_b64 a[78:79], v110 offset:1736
    ds_read_b128 a[108:111], v111 offset:2240
    v_mfma_f32_16x16x32_bf16 v[8:11], a[8:11], a[48:51], v[8:11]
    ds_read_b64 a[80:81], v110 offset:2240
    ds_read_b64 a[82:83], v110 offset:2248
    v_mfma_f32_16x16x32_bf16 v[12:15], a[8:11], a[52:55], v[12:15]
    ds_read_b128 a[112:115], v111 offset:1728
    ds_read_b64 a[84:85], v110 offset:2752
    v_mfma_f32_16x16x32_bf16 v[4:7], a[4:7], a[32:35], v[4:7]
    ds_read_b64 a[86:87], v110 offset:2760
    ds_read_b128 a[116:119], v111 offset:1216
    v_mfma_f32_16x16x32_bf16 v[8:11], a[12:15], a[44:47], v[8:11]
    ds_read_b64 a[88:89], v110 offset:3264
    ds_read_b64 a[90:91], v110 offset:3272
    v_mfma_f32_16x16x32_bf16 v[12:15], a[12:15], a[48:51], v[12:15]
    ds_read_b128 a[120:123], v111 offset:704
    ds_read_b64 a[92:93], v110 offset:3776
    v_mfma_f32_16x16x32_bf16 v[8:11], a[16:19], a[40:43], v[8:11]
    ds_read_b64 a[94:95], v110 offset:3784
    ds_read_b128 a[124:127], v111 offset:192
    v_mfma_f32_16x16x32_bf16 v[12:15], a[16:19], a[44:47], v[12:15]
    v_lshl_or_b32 v75, v75, 15, v75
    v_and_b32 v72, 0x10001, v75
    v_mfma_f32_16x16x32_bf16 v[8:11], a[20:23], a[36:39], v[8:11]
    v_lshrrev_b32 v73, 2, v75
    v_lshrrev_b32 v74, 4, v75
    v_mfma_f32_16x16x32_bf16 v[12:15], a[20:23], a[40:43], v[12:15]
    v_lshrrev_b32 v75, 6, v75
    v_and_b32 v73, 0x10001, v73
    v_mfma_f32_16x16x32_bf16 v[8:11], a[24:27], a[32:35], v[8:11]
    v_and_b32 v74, 0x10001, v74
    v_and_b32 v75, 0x10001, v75
    v_mfma_f32_16x16x32_bf16 v[12:15], a[24:27], a[36:39], v[12:15]
    s_lshl_b32 s85, s77, 7
    s_add_u32 s85, s85, s9
    v_mfma_f32_16x16x32_bf16 v[12:15], a[28:31], a[32:35], v[12:15]
    s_add_u32 s84, s85, 0x210000
    s_add_u32 s85, s85, 0x211800
    s_waitcnt lgkmcnt(0)
    v_mfma_f32_16x16x32_bf16 v[8:11], a[64:67], a[120:123], v[8:11]
    ds_read_b64 a[0:1], v110 offset:256
    ds_read_b64 a[2:3], v110 offset:264
    v_mfma_f32_16x16x32_bf16 v[12:15], a[64:67], a[124:127], v[12:15]
    ds_read_b128 a[32:35], v111 offset:3840
    ds_read_b64 a[4:5], v110 offset:768
    v_mfma_f32_16x16x32_bf16 v[0:3], a[64:67], a[96:99], v[0:3]
    ds_read_b64 a[6:7], v110 offset:776
    ds_read_b128 a[36:39], v111 offset:3328
    v_mfma_f32_16x16x32_bf16 v[8:11], a[68:71], a[116:119], v[8:11]
    ds_read_b64 a[8:9], v110 offset:1280
    ds_read_b64 a[10:11], v110 offset:1288
    v_mfma_f32_16x16x32_bf16 v[12:15], a[68:71], a[120:123], v[12:15]
    ds_read_b128 a[40:43], v111 offset:2816
    ds_read_b64 a[12:13], v110 offset:1792
    v_mfma_f32_16x16x32_bf16 v[4:7], a[64:67], a[100:103], v[4:7]
    ds_read_b64 a[14:15], v110 offset:1800
    ds_read_b128 a[44:47], v111 offset:2304
    v_mfma_f32_16x16x32_bf16 v[8:11], a[72:75], a[112:115], v[8:11]
    ds_read_b64 a[16:17], v110 offset:2304
    ds_read_b64 a[18:19], v110 offset:2312
    v_mfma_f32_16x16x32_bf16 v[12:15], a[72:75], a[116:119], v[12:15]
    ds_read_b128 a[48:51], v111 offset:1792
    ds_read_b64 a[20:21], v110 offset:2816
    v_mfma_f32_16x16x32_bf16 v[4:7], a[68:71], a[96:99], v[4:7]
    ds_read_b64 a[22:23], v110 offset:2824
    ds_read_b128 a[52:55], v111 offset:1280
    v_mfma_f32_16x16x32_bf16 v[8:11], a[76:79], a[108:111], v[8:11]
    ds_read_b64 a[24:25], v110 offset:3328
    ds_read_b64 a[26:27], v110 offset:3336
    v_mfma_f32_16x16x32_bf16 v[12:15], a[76:79], a[112:115], v[12:15]
    ds_read_b128 a[56:59], v111 offset:768
    ds_read_b64 a[28:29], v110 offset:3840
    v_mfma_f32_16x16x32_bf16 v[8:11], a[80:83], a[104:107], v[8:11]
    ds_read_b64 a[30:31], v110 offset:3848
    ds_read_b128 a[60:63], v111 offset:256
    v_mfma_f32_16x16x32_bf16 v[12:15], a[80:83], a[108:111], v[12:15]
    v_mfma_f32_16x16x32_bf16 v[8:11], a[84:87], a[100:103], v[8:11]
    v_mfma_f32_16x16x32_bf16 v[12:15], a[84:87], a[104:107], v[12:15]
    v_mfma_f32_16x16x32_bf16 v[8:11], a[88:91], a[96:99], v[8:11]
    v_mfma_f32_16x16x32_bf16 v[12:15], a[88:91], a[100:103], v[12:15]
    v_mfma_f32_16x16x32_bf16 v[12:15], a[92:95], a[96:99], v[12:15]
    s_waitcnt lgkmcnt(0)
    v_mfma_f32_16x16x32_bf16 v[8:11], a[0:3], a[56:59], v[8:11]
    ds_read_b64 a[64:65], v110 offset:320
    ds_read_b64 a[66:67], v110 offset:328
    v_mfma_f32_16x16x32_bf16 v[12:15], a[0:3], a[60:63], v[12:15]
    ds_read_b128 a[96:99], v111 offset:3904
    ds_read_b64 a[68:69], v110 offset:832
    v_mfma_f32_16x16x32_bf16 v[0:3], a[0:3], a[32:35], v[0:3]
    ds_read_b64 a[70:71], v110 offset:840
    ds_read_b128 a[100:103], v111 offset:3392
    v_mfma_f32_16x16x32_bf16 v[8:11], a[4:7], a[52:55], v[8:11]
    ds_read_b64 a[72:73], v110 offset:1344
    ds_read_b64 a[74:75], v110 offset:1352
    v_mfma_f32_16x16x32_bf16 v[12:15], a[4:7], a[56:59], v[12:15]
    ds_read_b128 a[104:107], v111 offset:2880
    ds_read_b64 a[76:77], v110 offset:1856
    v_mfma_f32_16x16x32_bf16 v[4:7], a[0:3], a[36:39], v[4:7]
    ds_read_b64 a[78:79], v110 offset:1864
    ds_read_b128 a[108:111], v111 offset:2368
    v_mfma_f32_16x16x32_bf16 v[8:11], a[8:11], a[48:51], v[8:11]
    ds_read_b64 a[80:81], v110 offset:2368
    ds_read_b64 a[82:83], v110 offset:2376
    v_mfma_f32_16x16x32_bf16 v[12:15], a[8:11], a[52:55], v[12:15]
    ds_read_b128 a[112:115], v111 offset:1856
    ds_read_b64 a[84:85], v110 offset:2880
    v_mfma_f32_16x16x32_bf16 v[4:7], a[4:7], a[32:35], v[4:7]
    ds_read_b64 a[86:87], v110 offset:2888
    ds_read_b128 a[116:119], v111 offset:1344
    v_mfma_f32_16x16x32_bf16 v[8:11], a[12:15], a[44:47], v[8:11]
    ds_read_b64 a[88:89], v110 offset:3392
    ds_read_b64 a[90:91], v110 offset:3400
    v_mfma_f32_16x16x32_bf16 v[12:15], a[12:15], a[48:51], v[12:15]
    ds_read_b128 a[120:123], v111 offset:832
    ds_read_b64 a[92:93], v110 offset:3904
    v_mfma_f32_16x16x32_bf16 v[8:11], a[16:19], a[40:43], v[8:11]
    ds_read_b64 a[94:95], v110 offset:3912
    ds_read_b128 a[124:127], v111 offset:320
    v_mfma_f32_16x16x32_bf16 v[12:15], a[16:19], a[44:47], v[12:15]
    v_mfma_f32_16x16x32_bf16 v[8:11], a[20:23], a[36:39], v[8:11]
    v_mfma_f32_16x16x32_bf16 v[12:15], a[20:23], a[40:43], v[12:15]
    v_mfma_f32_16x16x32_bf16 v[8:11], a[24:27], a[32:35], v[8:11]
    v_mfma_f32_16x16x32_bf16 v[12:15], a[24:27], a[36:39], v[12:15]
    v_mfma_f32_16x16x32_bf16 v[12:15], a[28:31], a[32:35], v[12:15]
    s_waitcnt lgkmcnt(0)
    v_mfma_f32_16x16x32_bf16 v[8:11], a[64:67], a[120:123], v[8:11]
    ds_read_b64 a[0:1], v110 offset:384
    ds_read_b64 a[2:3], v110 offset:392
    v_mfma_f32_16x16x32_bf16 v[12:15], a[64:67], a[124:127], v[12:15]
    ds_read_b128 a[32:35], v111 offset:3968
    ds_read_b64 a[4:5], v110 offset:896
    v_mfma_f32_16x16x32_bf16 v[0:3], a[64:67], a[96:99], v[0:3]
    ds_read_b64 a[6:7], v110 offset:904
    ds_read_b128 a[36:39], v111 offset:3456
    v_mfma_f32_16x16x32_bf16 v[8:11], a[68:71], a[116:119], v[8:11]
    ds_read_b64 a[8:9], v110 offset:1408
    ds_read_b64 a[10:11], v110 offset:1416
    v_mfma_f32_16x16x32_bf16 v[12:15], a[68:71], a[120:123], v[12:15]
    ds_read_b128 a[40:43], v111 offset:2944
    ds_read_b64 a[12:13], v110 offset:1920
    v_mfma_f32_16x16x32_bf16 v[4:7], a[64:67], a[100:103], v[4:7]
    ds_read_b64 a[14:15], v110 offset:1928
    ds_read_b128 a[44:47], v111 offset:2432
    v_mfma_f32_16x16x32_bf16 v[8:11], a[72:75], a[112:115], v[8:11]
    ds_read_b64 a[16:17], v110 offset:2432
    ds_read_b64 a[18:19], v110 offset:2440
    v_mfma_f32_16x16x32_bf16 v[12:15], a[72:75], a[116:119], v[12:15]
    ds_read_b128 a[48:51], v111 offset:1920
    ds_read_b64 a[20:21], v110 offset:2944
    v_mfma_f32_16x16x32_bf16 v[4:7], a[68:71], a[96:99], v[4:7]
    ds_read_b64 a[22:23], v110 offset:2952
    ds_read_b128 a[52:55], v111 offset:1408
    v_mfma_f32_16x16x32_bf16 v[8:11], a[76:79], a[108:111], v[8:11]
    ds_read_b64 a[24:25], v110 offset:3456
    ds_read_b64 a[26:27], v110 offset:3464
    v_mfma_f32_16x16x32_bf16 v[12:15], a[76:79], a[112:115], v[12:15]
    ds_read_b128 a[56:59], v111 offset:896
    ds_read_b64 a[28:29], v110 offset:3968
    v_mfma_f32_16x16x32_bf16 v[8:11], a[80:83], a[104:107], v[8:11]
    ds_read_b64 a[30:31], v110 offset:3976
    ds_read_b128 a[60:63], v111 offset:384
    v_mfma_f32_16x16x32_bf16 v[12:15], a[80:83], a[108:111], v[12:15]
    v_mfma_f32_16x16x32_bf16 v[8:11], a[84:87], a[100:103], v[8:11]
    v_mfma_f32_16x16x32_bf16 v[12:15], a[84:87], a[104:107], v[12:15]
    v_mfma_f32_16x16x32_bf16 v[8:11], a[88:91], a[96:99], v[8:11]
    v_mfma_f32_16x16x32_bf16 v[12:15], a[88:91], a[100:103], v[12:15]
    v_mfma_f32_16x16x32_bf16 v[12:15], a[92:95], a[96:99], v[12:15]
    s_waitcnt lgkmcnt(0)
    v_mfma_f32_16x16x32_bf16 v[8:11], a[0:3], a[56:59], v[8:11]
    ds_read_b64 a[64:65], v110 offset:448
    ds_read_b64 a[66:67], v110 offset:456
    v_mfma_f32_16x16x32_bf16 v[12:15], a[0:3], a[60:63], v[12:15]
    ds_read_b128 a[96:99], v111 offset:4032
    ds_read_b64 a[68:69], v110 offset:960
    v_mfma_f32_16x16x32_bf16 v[0:3], a[0:3], a[32:35], v[0:3]
    ds_read_b64 a[70:71], v110 offset:968
    ds_read_b128 a[100:103], v111 offset:3520
    v_mfma_f32_16x16x32_bf16 v[8:11], a[4:7], a[52:55], v[8:11]
    ds_read_b64 a[72:73], v110 offset:1472
    ds_read_b64 a[74:75], v110 offset:1480
    v_mfma_f32_16x16x32_bf16 v[12:15], a[4:7], a[56:59], v[12:15]
    ds_read_b128 a[104:107], v111 offset:3008
    ds_read_b64 a[76:77], v110 offset:1984
    v_mfma_f32_16x16x32_bf16 v[4:7], a[0:3], a[36:39], v[4:7]
    ds_read_b64 a[78:79], v110 offset:1992
    ds_read_b128 a[108:111], v111 offset:2496
    v_mfma_f32_16x16x32_bf16 v[8:11], a[8:11], a[48:51], v[8:11]
    ds_read_b64 a[80:81], v110 offset:2496
    ds_read_b64 a[82:83], v110 offset:2504
    v_mfma_f32_16x16x32_bf16 v[12:15], a[8:11], a[52:55], v[12:15]
    ds_read_b128 a[112:115], v111 offset:1984
    ds_read_b64 a[84:85], v110 offset:3008
    v_mfma_f32_16x16x32_bf16 v[4:7], a[4:7], a[32:35], v[4:7]
    ds_read_b64 a[86:87], v110 offset:3016
    ds_read_b128 a[116:119], v111 offset:1472
    v_mfma_f32_16x16x32_bf16 v[8:11], a[12:15], a[44:47], v[8:11]
    ds_read_b64 a[88:89], v110 offset:3520
    ds_read_b64 a[90:91], v110 offset:3528
    v_mfma_f32_16x16x32_bf16 v[12:15], a[12:15], a[48:51], v[12:15]
    ds_read_b128 a[120:123], v111 offset:960
    ds_read_b64 a[92:93], v110 offset:4032
    v_mfma_f32_16x16x32_bf16 v[8:11], a[16:19], a[40:43], v[8:11]
    ds_read_b64 a[94:95], v110 offset:4040
    ds_read_b128 a[124:127], v111 offset:448
    v_mfma_f32_16x16x32_bf16 v[12:15], a[16:19], a[44:47], v[12:15]
    v_mfma_f32_16x16x32_bf16 v[8:11], a[20:23], a[36:39], v[8:11]
    v_mfma_f32_16x16x32_bf16 v[12:15], a[20:23], a[40:43], v[12:15]
    v_mfma_f32_16x16x32_bf16 v[8:11], a[24:27], a[32:35], v[8:11]
    v_mfma_f32_16x16x32_bf16 v[12:15], a[24:27], a[36:39], v[12:15]
    v_mfma_f32_16x16x32_bf16 v[12:15], a[28:31], a[32:35], v[12:15]
    s_waitcnt lgkmcnt(0)
    v_mov_b32 v123, 4
    ds_write_b32 v120, v123 offset:32
    v_mfma_f32_16x16x32_bf16 v[0:3], a[64:67], a[96:99], v[0:3]
    v_mfma_f32_16x16x32_bf16 v[4:7], a[64:67], a[100:103], v[4:7]
    v_mfma_f32_16x16x32_bf16 v[4:7], a[68:71], a[96:99], v[4:7]
    v_mfma_f32_16x16x32_bf16 v[8:11], a[64:67], a[120:123], v[8:11]
    v_mfma_f32_16x16x32_bf16 v[12:15], a[64:67], a[124:127], v[12:15]
    v_mfma_f32_16x16x32_bf16 v[8:11], a[68:71], a[116:119], v[8:11]
    s_nop 2
    v_fma_f32 v0, v56, s10, v0
    v_fma_f32 v1, v57, s10, v1
    v_mfma_f32_16x16x32_bf16 v[12:15], a[68:71], a[120:123], v[12:15]
    v_fma_f32 v2, v58, s10, v2
    v_fma_f32 v3, v59, s10, v3
    v_mfma_f32_16x16x32_bf16 v[8:11], a[72:75], a[112:115], v[8:11]
    v_fma_f32 v4, v60, s10, v4
    v_fma_f32 v5, v61, s10, v5
    v_mfma_f32_16x16x32_bf16 v[12:15], a[72:75], a[116:119], v[12:15]
    v_fma_f32 v6, v62, s10, v6
    v_fma_f32 v7, v63, s10, v7
    v_mfma_f32_16x16x32_bf16 v[8:11], a[76:79], a[108:111], v[8:11]
    v_cvt_pk_f16_f32 v16, v0, v1
    v_cvt_pk_f16_f32 v17, v2, v3
    v_mfma_f32_16x16x32_bf16 v[12:15], a[76:79], a[112:115], v[12:15]
    v_cvt_pk_f16_f32 v18, v4, v5
    v_cvt_pk_f16_f32 v19, v6, v7
    v_mfma_f32_16x16x32_bf16 v[8:11], a[80:83], a[104:107], v[8:11]
    s_nop 1
    v_permlane16_swap_b32 v16, v18
    v_mfma_f32_16x16x32_bf16 v[12:15], a[80:83], a[108:111], v[12:15]
    v_permlane16_swap_b32 v17, v19
    s_nop 0
    v_mfma_f32_16x16x32_bf16 v[8:11], a[84:87], a[100:103], v[8:11]
    v_and_or_b32 v16, v16, s83, v72
    v_and_or_b32 v17, v17, s83, v73
    v_mfma_f32_16x16x32_bf16 v[12:15], a[84:87], a[104:107], v[12:15]
    v_and_or_b32 v18, v18, s83, v74
    v_and_or_b32 v19, v19, s83, v75
    v_mfma_f32_16x16x32_bf16 v[8:11], a[88:91], a[96:99], v[8:11]
    buffer_store_dwordx4 v[16:19], v100, s[44:47], s84 offen sc1
    v_mfma_f32_16x16x32_bf16 v[12:15], a[88:91], a[100:103], v[12:15]
    v_mfma_f32_16x16x32_bf16 v[12:15], a[92:95], a[96:99], v[12:15]
    s_setprio 3
    s_nop 3
    v_fma_f32 v8, v64, s10, v8
    v_fma_f32 v9, v65, s10, v9
    v_fma_f32 v10, v66, s10, v10
    v_fma_f32 v11, v67, s10, v11
    v_fma_f32 v12, v68, s10, v12
    v_fma_f32 v13, v69, s10, v13
    v_fma_f32 v14, v70, s10, v14
    v_fma_f32 v15, v71, s10, v15
    v_cvt_pk_f16_f32 v20, v8, v9
    v_cvt_pk_f16_f32 v21, v10, v11
    v_cvt_pk_f16_f32 v22, v12, v13
    v_cvt_pk_f16_f32 v23, v14, v15
    s_nop 1
    v_permlane16_swap_b32 v20, v22
    v_permlane16_swap_b32 v21, v23
    s_nop 0
    v_and_or_b32 v20, v20, s83, v72
    v_and_or_b32 v21, v21, s83, v73
    v_and_or_b32 v22, v22, s83, v74
    v_and_or_b32 v23, v23, s83, v75
    buffer_store_dwordx4 v[20:23], v100, s[44:47], s85 offen sc1
    s_branch CW_54
CV_53:
    ds_read_b64 a[0:1], v110 offset:0
    ds_read_b64 a[2:3], v110 offset:8
    ds_read_b128 a[32:35], v111 offset:3584
    ds_read_b64 a[4:5], v110 offset:512
    ds_read_b64 a[6:7], v110 offset:520
    ds_read_b128 a[36:39], v111 offset:3072
    ds_read_b64 a[8:9], v110 offset:1024
    ds_read_b64 a[10:11], v110 offset:1032
    ds_read_b128 a[40:43], v111 offset:2560
    ds_read_b64 a[12:13], v110 offset:1536
    ds_read_b64 a[14:15], v110 offset:1544
    ds_read_b128 a[44:47], v111 offset:2048
    ds_read_b64 a[16:17], v110 offset:2048
    ds_read_b64 a[18:19], v110 offset:2056
    ds_read_b128 a[48:51], v111 offset:1536
    ds_read_b64 a[20:21], v110 offset:2560
    ds_read_b64 a[22:23], v110 offset:2568
    ds_read_b128 a[52:55], v111 offset:1024
    ds_read_b64 v[48:49], v108 offset:2560
    ds_read_b64 v[50:51], v108 offset:2048
    ds_read_b64 v[52:53], v108 offset:1536
    ds_read_b64 v[54:55], v108 offset:1024
    s_waitcnt lgkmcnt(0)
    v_mfma_f32_16x16x32_bf16 v[8:11], a[0:3], a[48:51], 0
    ds_read_b64 a[64:65], v110 offset:64
    ds_read_b64 a[66:67], v110 offset:72
    v_mfma_f32_16x16x32_bf16 v[12:15], a[0:3], a[52:55], 0
    ds_read_b128 a[96:99], v111 offset:3648
    ds_read_b64 a[68:69], v110 offset:576
    v_mfma_f32_16x16x32_bf16 v[0:3], a[0:3], a[40:43], 0
    ds_read_b64 a[70:71], v110 offset:584
    ds_read_b128 a[100:103], v111 offset:3136
    v_mfma_f32_16x16x32_bf16 v[8:11], a[4:7], a[44:47], v[8:11]
    ds_read_b64 a[72:73], v110 offset:1088
    ds_read_b64 a[74:75], v110 offset:1096
    v_mfma_f32_16x16x32_bf16 v[12:15], a[4:7], a[48:51], v[12:15]
    ds_read_b128 a[104:107], v111 offset:2624
    ds_read_b64 a[76:77], v110 offset:1600
    v_mfma_f32_16x16x32_bf16 v[4:7], a[0:3], a[44:47], 0
    ds_read_b64 a[78:79], v110 offset:1608
    ds_read_b128 a[108:111], v111 offset:2112
    v_mfma_f32_16x16x32_bf16 v[8:11], a[8:11], a[40:43], v[8:11]
    ds_read_b64 a[80:81], v110 offset:2112
    ds_read_b64 a[82:83], v110 offset:2120
    v_mfma_f32_16x16x32_bf16 v[12:15], a[8:11], a[44:47], v[12:15]
    ds_read_b128 a[112:115], v111 offset:1600
    ds_read_b64 a[84:85], v110 offset:2624
    v_mfma_f32_16x16x32_bf16 v[0:3], a[4:7], a[36:39], v[0:3]
    ds_read_b64 a[86:87], v110 offset:2632
    ds_read_b128 a[116:119], v111 offset:1088
    v_mfma_f32_16x16x32_bf16 v[8:11], a[12:15], a[36:39], v[8:11]
    v_and_b32 v56, 0xffff0000, v49
    v_lshlrev_b32 v57, 16, v49
    v_mfma_f32_16x16x32_bf16 v[12:15], a[12:15], a[40:43], v[12:15]
    v_and_b32 v58, 0xffff0000, v48
    v_lshlrev_b32 v59, 16, v48
    v_mfma_f32_16x16x32_bf16 v[4:7], a[4:7], a[40:43], v[4:7]
    v_and_b32 v60, 0xffff0000, v51
    v_lshlrev_b32 v61, 16, v51
    v_mfma_f32_16x16x32_bf16 v[8:11], a[16:19], a[32:35], v[8:11]
    v_and_b32 v62, 0xffff0000, v50
    v_lshlrev_b32 v63, 16, v50
    v_mfma_f32_16x16x32_bf16 v[12:15], a[16:19], a[36:39], v[12:15]
    v_and_b32 v64, 0xffff0000, v53
    v_lshlrev_b32 v65, 16, v53
    v_mfma_f32_16x16x32_bf16 v[0:3], a[8:11], a[32:35], v[0:3]
    v_and_b32 v66, 0xffff0000, v52
    v_lshlrev_b32 v67, 16, v52
    v_mfma_f32_16x16x32_bf16 v[12:15], a[20:23], a[32:35], v[12:15]
    v_and_b32 v68, 0xffff0000, v55
    v_lshlrev_b32 v69, 16, v55
    v_mfma_f32_16x16x32_bf16 v[4:7], a[8:11], a[36:39], v[4:7]
    v_and_b32 v70, 0xffff0000, v54
    v_lshlrev_b32 v71, 16, v54
    v_mfma_f32_16x16x32_bf16 v[4:7], a[12:15], a[32:35], v[4:7]
    v_bfe_u32 v101, v127, 2, 3
    v_lshlrev_b32 v100, 8, v101
    s_waitcnt lgkmcnt(0)
    v_mfma_f32_16x16x32_bf16 v[8:11], a[64:67], a[112:115], v[8:11]
    ds_read_b64 a[0:1], v110 offset:128
    ds_read_b64 a[2:3], v110 offset:136
    v_mfma_f32_16x16x32_bf16 v[12:15], a[64:67], a[116:119], v[12:15]
    ds_read_b128 a[32:35], v111 offset:3712
    ds_read_b64 a[4:5], v110 offset:640
    v_mfma_f32_16x16x32_bf16 v[0:3], a[64:67], a[104:107], v[0:3]
    ds_read_b64 a[6:7], v110 offset:648
    ds_read_b128 a[36:39], v111 offset:3200
    v_mfma_f32_16x16x32_bf16 v[8:11], a[68:71], a[108:111], v[8:11]
    ds_read_b64 a[8:9], v110 offset:1152
    ds_read_b64 a[10:11], v110 offset:1160
    v_mfma_f32_16x16x32_bf16 v[12:15], a[68:71], a[112:115], v[12:15]
    ds_read_b128 a[40:43], v111 offset:2688
    ds_read_b64 a[12:13], v110 offset:1664
    v_mfma_f32_16x16x32_bf16 v[4:7], a[64:67], a[108:111], v[4:7]
    ds_read_b64 a[14:15], v110 offset:1672
    ds_read_b128 a[44:47], v111 offset:2176
    v_mfma_f32_16x16x32_bf16 v[8:11], a[72:75], a[104:107], v[8:11]
    ds_read_b64 a[16:17], v110 offset:2176
    ds_read_b64 a[18:19], v110 offset:2184
    v_mfma_f32_16x16x32_bf16 v[12:15], a[72:75], a[108:111], v[12:15]
    ds_read_b128 a[48:51], v111 offset:1664
    ds_read_b64 a[20:21], v110 offset:2688
    v_mfma_f32_16x16x32_bf16 v[0:3], a[68:71], a[100:103], v[0:3]
    ds_read_b64 a[22:23], v110 offset:2696
    ds_read_b128 a[52:55], v111 offset:1152
    v_mfma_f32_16x16x32_bf16 v[8:11], a[76:79], a[100:103], v[8:11]
    v_lshl_add_u32 v100, v104, 4, v100
    v_lshrrev_b32 v101, 5, v127
    v_mfma_f32_16x16x32_bf16 v[12:15], a[76:79], a[104:107], v[12:15]
    v_lshl_add_u32 v100, v101, 6, v100
    v_lshrrev_b32 v75, 1, v100
    v_mfma_f32_16x16x32_bf16 v[4:7], a[68:71], a[104:107], v[4:7]
    v_and_b32 v75, 24, v75
    v_bfe_u32 v75, s72, v75, 8
    v_mfma_f32_16x16x32_bf16 v[8:11], a[80:83], a[96:99], v[8:11]
    v_lshl_or_b32 v75, v75, 15, v75
    v_and_b32 v72, 0x10001, v75
    v_mfma_f32_16x16x32_bf16 v[12:15], a[80:83], a[100:103], v[12:15]
    v_lshrrev_b32 v73, 2, v75
    v_lshrrev_b32 v74, 4, v75
    v_mfma_f32_16x16x32_bf16 v[0:3], a[72:75], a[96:99], v[0:3]
    v_lshrrev_b32 v75, 6, v75
    v_and_b32 v73, 0x10001, v73
    v_mfma_f32_16x16x32_bf16 v[12:15], a[84:87], a[96:99], v[12:15]
    v_and_b32 v74, 0x10001, v74
    v_and_b32 v75, 0x10001, v75
    v_mfma_f32_16x16x32_bf16 v[4:7], a[72:75], a[100:103], v[4:7]
    s_lshl_b32 s85, s77, 7
    s_add_u32 s85, s85, s9
    v_mfma_f32_16x16x32_bf16 v[4:7], a[76:79], a[96:99], v[4:7]
    s_add_u32 s84, s85, 0x210800
    s_add_u32 s85, s85, 0x211000
    s_waitcnt lgkmcnt(0)
    v_mfma_f32_16x16x32_bf16 v[8:11], a[0:3], a[48:51], v[8:11]
    ds_read_b64 a[64:65], v110 offset:192
    ds_read_b64 a[66:67], v110 offset:200
    v_mfma_f32_16x16x32_bf16 v[12:15], a[0:3], a[52:55], v[12:15]
    ds_read_b128 a[96:99], v111 offset:3776
    ds_read_b64 a[68:69], v110 offset:704
    v_mfma_f32_16x16x32_bf16 v[0:3], a[0:3], a[40:43], v[0:3]
    ds_read_b64 a[70:71], v110 offset:712
    ds_read_b128 a[100:103], v111 offset:3264
    v_mfma_f32_16x16x32_bf16 v[8:11], a[4:7], a[44:47], v[8:11]
    ds_read_b64 a[72:73], v110 offset:1216
    ds_read_b64 a[74:75], v110 offset:1224
    v_mfma_f32_16x16x32_bf16 v[12:15], a[4:7], a[48:51], v[12:15]
    ds_read_b128 a[104:107], v111 offset:2752
    ds_read_b64 a[76:77], v110 offset:1728
    v_mfma_f32_16x16x32_bf16 v[4:7], a[0:3], a[44:47], v[4:7]
    ds_read_b64 a[78:79], v110 offset:1736
    ds_read_b128 a[108:111], v111 offset:2240
    v_mfma_f32_16x16x32_bf16 v[8:11], a[8:11], a[40:43], v[8:11]
    ds_read_b64 a[80:81], v110 offset:2240
    ds_read_b64 a[82:83], v110 offset:2248
    v_mfma_f32_16x16x32_bf16 v[12:15], a[8:11], a[44:47], v[12:15]
    ds_read_b128 a[112:115], v111 offset:1728
    ds_read_b64 a[84:85], v110 offset:2752
    v_mfma_f32_16x16x32_bf16 v[0:3], a[4:7], a[36:39], v[0:3]
    ds_read_b64 a[86:87], v110 offset:2760
    ds_read_b128 a[116:119], v111 offset:1216
    v_mfma_f32_16x16x32_bf16 v[8:11], a[12:15], a[36:39], v[8:11]
    v_mfma_f32_16x16x32_bf16 v[12:15], a[12:15], a[40:43], v[12:15]
    v_mfma_f32_16x16x32_bf16 v[4:7], a[4:7], a[40:43], v[4:7]
    v_mfma_f32_16x16x32_bf16 v[8:11], a[16:19], a[32:35], v[8:11]
    v_mfma_f32_16x16x32_bf16 v[12:15], a[16:19], a[36:39], v[12:15]
    v_mfma_f32_16x16x32_bf16 v[0:3], a[8:11], a[32:35], v[0:3]
    v_mfma_f32_16x16x32_bf16 v[12:15], a[20:23], a[32:35], v[12:15]
    v_mfma_f32_16x16x32_bf16 v[4:7], a[8:11], a[36:39], v[4:7]
    v_mfma_f32_16x16x32_bf16 v[4:7], a[12:15], a[32:35], v[4:7]
    s_waitcnt lgkmcnt(0)
    v_mfma_f32_16x16x32_bf16 v[8:11], a[64:67], a[112:115], v[8:11]
    ds_read_b64 a[0:1], v110 offset:256
    ds_read_b64 a[2:3], v110 offset:264
    v_mfma_f32_16x16x32_bf16 v[12:15], a[64:67], a[116:119], v[12:15]
    ds_read_b128 a[32:35], v111 offset:3840
    ds_read_b64 a[4:5], v110 offset:768
    v_mfma_f32_16x16x32_bf16 v[0:3], a[64:67], a[104:107], v[0:3]
    ds_read_b64 a[6:7], v110 offset:776
    ds_read_b128 a[36:39], v111 offset:3328
    v_mfma_f32_16x16x32_bf16 v[8:11], a[68:71], a[108:111], v[8:11]
    ds_read_b64 a[8:9], v110 offset:1280
    ds_read_b64 a[10:11], v110 offset:1288
    v_mfma_f32_16x16x32_bf16 v[12:15], a[68:71], a[112:115], v[12:15]
    ds_read_b128 a[40:43], v111 offset:2816
    ds_read_b64 a[12:13], v110 offset:1792
    v_mfma_f32_16x16x32_bf16 v[4:7], a[64:67], a[108:111], v[4:7]
    ds_read_b64 a[14:15], v110 offset:1800
    ds_read_b128 a[44:47], v111 offset:2304
    v_mfma_f32_16x16x32_bf16 v[8:11], a[72:75], a[104:107], v[8:11]
    ds_read_b64 a[16:17], v110 offset:2304
    ds_read_b64 a[18:19], v110 offset:2312
    v_mfma_f32_16x16x32_bf16 v[12:15], a[72:75], a[108:111], v[12:15]
    ds_read_b128 a[48:51], v111 offset:1792
    ds_read_b64 a[20:21], v110 offset:2816
    v_mfma_f32_16x16x32_bf16 v[0:3], a[68:71], a[100:103], v[0:3]
    ds_read_b64 a[22:23], v110 offset:2824
    ds_read_b128 a[52:55], v111 offset:1280
    v_mfma_f32_16x16x32_bf16 v[8:11], a[76:79], a[100:103], v[8:11]
    v_mfma_f32_16x16x32_bf16 v[12:15], a[76:79], a[104:107], v[12:15]
    v_mfma_f32_16x16x32_bf16 v[4:7], a[68:71], a[104:107], v[4:7]
    v_mfma_f32_16x16x32_bf16 v[8:11], a[80:83], a[96:99], v[8:11]
    v_mfma_f32_16x16x32_bf16 v[12:15], a[80:83], a[100:103], v[12:15]
    v_mfma_f32_16x16x32_bf16 v[0:3], a[72:75], a[96:99], v[0:3]
    v_mfma_f32_16x16x32_bf16 v[12:15], a[84:87], a[96:99], v[12:15]
    v_mfma_f32_16x16x32_bf16 v[4:7], a[72:75], a[100:103], v[4:7]
    v_mfma_f32_16x16x32_bf16 v[4:7], a[76:79], a[96:99], v[4:7]
    s_waitcnt lgkmcnt(0)
    v_mfma_f32_16x16x32_bf16 v[8:11], a[0:3], a[48:51], v[8:11]
    ds_read_b64 a[64:65], v110 offset:320
    ds_read_b64 a[66:67], v110 offset:328
    v_mfma_f32_16x16x32_bf16 v[12:15], a[0:3], a[52:55], v[12:15]
    ds_read_b128 a[96:99], v111 offset:3904
    ds_read_b64 a[68:69], v110 offset:832
    v_mfma_f32_16x16x32_bf16 v[0:3], a[0:3], a[40:43], v[0:3]
    ds_read_b64 a[70:71], v110 offset:840
    ds_read_b128 a[100:103], v111 offset:3392
    v_mfma_f32_16x16x32_bf16 v[8:11], a[4:7], a[44:47], v[8:11]
    ds_read_b64 a[72:73], v110 offset:1344
    ds_read_b64 a[74:75], v110 offset:1352
    v_mfma_f32_16x16x32_bf16 v[12:15], a[4:7], a[48:51], v[12:15]
    ds_read_b128 a[104:107], v111 offset:2880
    ds_read_b64 a[76:77], v110 offset:1856
    v_mfma_f32_16x16x32_bf16 v[4:7], a[0:3], a[44:47], v[4:7]
    ds_read_b64 a[78:79], v110 offset:1864
    ds_read_b128 a[108:111], v111 offset:2368
    v_mfma_f32_16x16x32_bf16 v[8:11], a[8:11], a[40:43], v[8:11]
    ds_read_b64 a[80:81], v110 offset:2368
    ds_read_b64 a[82:83], v110 offset:2376
    v_mfma_f32_16x16x32_bf16 v[12:15], a[8:11], a[44:47], v[12:15]
    ds_read_b128 a[112:115], v111 offset:1856
    ds_read_b64 a[84:85], v110 offset:2880
    v_mfma_f32_16x16x32_bf16 v[0:3], a[4:7], a[36:39], v[0:3]
    ds_read_b64 a[86:87], v110 offset:2888
    ds_read_b128 a[116:119], v111 offset:1344
    v_mfma_f32_16x16x32_bf16 v[8:11], a[12:15], a[36:39], v[8:11]
    v_mfma_f32_16x16x32_bf16 v[12:15], a[12:15], a[40:43], v[12:15]
    v_mfma_f32_16x16x32_bf16 v[4:7], a[4:7], a[40:43], v[4:7]
    v_mfma_f32_16x16x32_bf16 v[8:11], a[16:19], a[32:35], v[8:11]
    v_mfma_f32_16x16x32_bf16 v[12:15], a[16:19], a[36:39], v[12:15]
    v_mfma_f32_16x16x32_bf16 v[0:3], a[8:11], a[32:35], v[0:3]
    v_mfma_f32_16x16x32_bf16 v[12:15], a[20:23], a[32:35], v[12:15]
    v_mfma_f32_16x16x32_bf16 v[4:7], a[8:11], a[36:39], v[4:7]
    v_mfma_f32_16x16x32_bf16 v[4:7], a[12:15], a[32:35], v[4:7]
    s_waitcnt lgkmcnt(0)
    v_mfma_f32_16x16x32_bf16 v[8:11], a[64:67], a[112:115], v[8:11]
    ds_read_b64 a[0:1], v110 offset:384
    ds_read_b64 a[2:3], v110 offset:392
    v_mfma_f32_16x16x32_bf16 v[12:15], a[64:67], a[116:119], v[12:15]
    ds_read_b128 a[32:35], v111 offset:3968
    ds_read_b64 a[4:5], v110 offset:896
    v_mfma_f32_16x16x32_bf16 v[0:3], a[64:67], a[104:107], v[0:3]
    ds_read_b64 a[6:7], v110 offset:904
    ds_read_b128 a[36:39], v111 offset:3456
    v_mfma_f32_16x16x32_bf16 v[8:11], a[68:71], a[108:111], v[8:11]
    ds_read_b64 a[8:9], v110 offset:1408
    ds_read_b64 a[10:11], v110 offset:1416
    v_mfma_f32_16x16x32_bf16 v[12:15], a[68:71], a[112:115], v[12:15]
    ds_read_b128 a[40:43], v111 offset:2944
    ds_read_b64 a[12:13], v110 offset:1920
    v_mfma_f32_16x16x32_bf16 v[4:7], a[64:67], a[108:111], v[4:7]
    ds_read_b64 a[14:15], v110 offset:1928
    ds_read_b128 a[44:47], v111 offset:2432
    v_mfma_f32_16x16x32_bf16 v[8:11], a[72:75], a[104:107], v[8:11]
    ds_read_b64 a[16:17], v110 offset:2432
    ds_read_b64 a[18:19], v110 offset:2440
    v_mfma_f32_16x16x32_bf16 v[12:15], a[72:75], a[108:111], v[12:15]
    ds_read_b128 a[48:51], v111 offset:1920
    ds_read_b64 a[20:21], v110 offset:2944
    v_mfma_f32_16x16x32_bf16 v[0:3], a[68:71], a[100:103], v[0:3]
    ds_read_b64 a[22:23], v110 offset:2952
    ds_read_b128 a[52:55], v111 offset:1408
    v_mfma_f32_16x16x32_bf16 v[8:11], a[76:79], a[100:103], v[8:11]
    v_mfma_f32_16x16x32_bf16 v[12:15], a[76:79], a[104:107], v[12:15]
    v_mfma_f32_16x16x32_bf16 v[4:7], a[68:71], a[104:107], v[4:7]
    v_mfma_f32_16x16x32_bf16 v[8:11], a[80:83], a[96:99], v[8:11]
    v_mfma_f32_16x16x32_bf16 v[12:15], a[80:83], a[100:103], v[12:15]
    v_mfma_f32_16x16x32_bf16 v[0:3], a[72:75], a[96:99], v[0:3]
    v_mfma_f32_16x16x32_bf16 v[12:15], a[84:87], a[96:99], v[12:15]
    v_mfma_f32_16x16x32_bf16 v[4:7], a[72:75], a[100:103], v[4:7]
    v_mfma_f32_16x16x32_bf16 v[4:7], a[76:79], a[96:99], v[4:7]
    s_waitcnt lgkmcnt(0)
    v_mfma_f32_16x16x32_bf16 v[8:11], a[0:3], a[48:51], v[8:11]
    ds_read_b64 a[64:65], v110 offset:448
    ds_read_b64 a[66:67], v110 offset:456
    v_mfma_f32_16x16x32_bf16 v[12:15], a[0:3], a[52:55], v[12:15]
    ds_read_b128 a[96:99], v111 offset:4032
    ds_read_b64 a[68:69], v110 offset:960
    v_mfma_f32_16x16x32_bf16 v[0:3], a[0:3], a[40:43], v[0:3]
    ds_read_b64 a[70:71], v110 offset:968
    ds_read_b128 a[100:103], v111 offset:3520
    v_mfma_f32_16x16x32_bf16 v[8:11], a[4:7], a[44:47], v[8:11]
    ds_read_b64 a[72:73], v110 offset:1472
    ds_read_b64 a[74:75], v110 offset:1480
    v_mfma_f32_16x16x32_bf16 v[12:15], a[4:7], a[48:51], v[12:15]
    ds_read_b128 a[104:107], v111 offset:3008
    ds_read_b64 a[76:77], v110 offset:1984
    v_mfma_f32_16x16x32_bf16 v[4:7], a[0:3], a[44:47], v[4:7]
    ds_read_b64 a[78:79], v110 offset:1992
    ds_read_b128 a[108:111], v111 offset:2496
    v_mfma_f32_16x16x32_bf16 v[8:11], a[8:11], a[40:43], v[8:11]
    ds_read_b64 a[80:81], v110 offset:2496
    ds_read_b64 a[82:83], v110 offset:2504
    v_mfma_f32_16x16x32_bf16 v[12:15], a[8:11], a[44:47], v[12:15]
    ds_read_b128 a[112:115], v111 offset:1984
    ds_read_b64 a[84:85], v110 offset:3008
    v_mfma_f32_16x16x32_bf16 v[0:3], a[4:7], a[36:39], v[0:3]
    ds_read_b64 a[86:87], v110 offset:3016
    ds_read_b128 a[116:119], v111 offset:1472
    v_mfma_f32_16x16x32_bf16 v[8:11], a[12:15], a[36:39], v[8:11]
    v_mfma_f32_16x16x32_bf16 v[12:15], a[12:15], a[40:43], v[12:15]
    v_mfma_f32_16x16x32_bf16 v[4:7], a[4:7], a[40:43], v[4:7]
    v_mfma_f32_16x16x32_bf16 v[8:11], a[16:19], a[32:35], v[8:11]
    v_mfma_f32_16x16x32_bf16 v[12:15], a[16:19], a[36:39], v[12:15]
    v_mfma_f32_16x16x32_bf16 v[0:3], a[8:11], a[32:35], v[0:3]
    v_mfma_f32_16x16x32_bf16 v[12:15], a[20:23], a[32:35], v[12:15]
    v_mfma_f32_16x16x32_bf16 v[4:7], a[8:11], a[36:39], v[4:7]
    v_mfma_f32_16x16x32_bf16 v[4:7], a[12:15], a[32:35], v[4:7]
    s_waitcnt lgkmcnt(0)
    v_mov_b32 v123, 4
    ds_write_b32 v120, v123 offset:32
    v_mfma_f32_16x16x32_bf16 v[0:3], a[64:67], a[104:107], v[0:3]
    v_mfma_f32_16x16x32_bf16 v[4:7], a[64:67], a[108:111], v[4:7]
    v_mfma_f32_16x16x32_bf16 v[0:3], a[68:71], a[100:103], v[0:3]
    v_mfma_f32_16x16x32_bf16 v[4:7], a[68:71], a[104:107], v[4:7]
    v_mfma_f32_16x16x32_bf16 v[0:3], a[72:75], a[96:99], v[0:3]
    v_mfma_f32_16x16x32_bf16 v[4:7], a[72:75], a[100:103], v[4:7]
    v_mfma_f32_16x16x32_bf16 v[4:7], a[76:79], a[96:99], v[4:7]
    v_mfma_f32_16x16x32_bf16 v[8:11], a[64:67], a[112:115], v[8:11]
    v_mfma_f32_16x16x32_bf16 v[12:15], a[64:67], a[116:119], v[12:15]
    v_mfma_f32_16x16x32_bf16 v[8:11], a[68:71], a[108:111], v[8:11]
    s_nop 2
    v_fma_f32 v0, v56, s10, v0
    v_fma_f32 v1, v57, s10, v1
    v_mfma_f32_16x16x32_bf16 v[12:15], a[68:71], a[112:115], v[12:15]
    v_fma_f32 v2, v58, s10, v2
    v_fma_f32 v3, v59, s10, v3
    v_mfma_f32_16x16x32_bf16 v[8:11], a[72:75], a[104:107], v[8:11]
    v_fma_f32 v4, v60, s10, v4
    v_fma_f32 v5, v61, s10, v5
    v_mfma_f32_16x16x32_bf16 v[12:15], a[72:75], a[108:111], v[12:15]
    v_fma_f32 v6, v62, s10, v6
    v_fma_f32 v7, v63, s10, v7
    v_mfma_f32_16x16x32_bf16 v[8:11], a[76:79], a[100:103], v[8:11]
    v_cvt_pk_f16_f32 v16, v0, v1
    v_cvt_pk_f16_f32 v17, v2, v3
    v_mfma_f32_16x16x32_bf16 v[12:15], a[76:79], a[104:107], v[12:15]
    v_cvt_pk_f16_f32 v18, v4, v5
    v_cvt_pk_f16_f32 v19, v6, v7
    v_mfma_f32_16x16x32_bf16 v[8:11], a[80:83], a[96:99], v[8:11]
    s_nop 1
    v_permlane16_swap_b32 v16, v18
    v_mfma_f32_16x16x32_bf16 v[12:15], a[80:83], a[100:103], v[12:15]
    v_permlane16_swap_b32 v17, v19
    s_nop 0
    v_mfma_f32_16x16x32_bf16 v[12:15], a[84:87], a[96:99], v[12:15]
    v_and_or_b32 v16, v16, s83, v72
    v_and_or_b32 v17, v17, s83, v73
    v_and_or_b32 v18, v18, s83, v74
    v_and_or_b32 v19, v19, s83, v75
    buffer_store_dwordx4 v[16:19], v100, s[44:47], s84 offen sc1
    s_setprio 3
    v_fma_f32 v8, v64, s10, v8
    v_fma_f32 v9, v65, s10, v9
    v_fma_f32 v10, v66, s10, v10
    v_fma_f32 v11, v67, s10, v11
    v_fma_f32 v12, v68, s10, v12
    v_fma_f32 v13, v69, s10, v13
    v_fma_f32 v14, v70, s10, v14
    v_fma_f32 v15, v71, s10, v15
    v_cvt_pk_f16_f32 v20, v8, v9
    v_cvt_pk_f16_f32 v21, v10, v11
    v_cvt_pk_f16_f32 v22, v12, v13
    v_cvt_pk_f16_f32 v23, v14, v15
    s_nop 1
    v_permlane16_swap_b32 v20, v22
    v_permlane16_swap_b32 v21, v23
    s_nop 0
    v_and_or_b32 v20, v20, s83, v72
    v_and_or_b32 v21, v21, s83, v73
    v_and_or_b32 v22, v22, s83, v74
    v_and_or_b32 v23, v23, s83, v75
    buffer_store_dwordx4 v[20:23], v100, s[44:47], s85 offen sc1
CW_54:
    s_waitcnt vmcnt(2)
    v_cmp_ne_u32 vcc, s87, v99
    s_cmp_eq_u64 vcc, 0
    s_cselect_b32 s88, 32, 0
    s_cmp_lg_u32 s88, 32
    s_cbranch_scc1 KF_55
KB_56:
    s_cmp_lt_u32 s7, 4
    s_cbranch_scc1 CE_57
    s_mov_b32 s75, 65536
LS_58:
    ds_read_b32 v114, v115 offset:32
    s_sub_u32 s75, s75, 1
    s_cmp_eq_u32 s75, 0
    s_cbranch_scc1 LD_59
    s_waitcnt lgkmcnt(0)
    v_cmp_gt_u32 vcc, 4, v114
    s_cbranch_vccnz LS_58
LD_59:
    s_waitcnt lgkmcnt(0)
L_CFIN:
    v_mul_u32_u24 v100, 8448, v126
    v_lshl_add_u32 v100, v125, 4, v100
    s_lshl2_add_u32 s84, s5, s76
    s_mul_i32 s84, s84, 67584
    s_lshl_b32 s12, s4, 8
    s_add_u32 s84, s84, s12
    s_add_u32 s84, s84, 0x210000
    s_add_u32 s85, s84, 33792
    v_and_b32 v106, 1, v126
    v_lshlrev_b32 v101, 4, v106
    v_and_b32 v107, 0x380, v122
    v_lshl_add_u32 v107, v104, 5, v107
    v_and_b32 v108, 4, v127
    v_lshl_add_u32 v107, v108, 2, v107
    v_xor_b32 v101, v101, v107
    s_lshl_b32 s12, s78, 6
    v_xor_b32 v101, s12, v101
    s_lshl_b32 s12, s78, 11
    s_add_u32 s12, s12, s81
    s_add_u32 s12, s12, 8192
    v_add_u32 v101, s12, v101
    v_xor_b32 v107, 32, v101
    v_mul_u32_u24 v102, 16640, v106
    v_bfe_u32 v106, v127, 2, 2
    v_lshl_add_u32 v108, v104, 3, v106
    v_lshl_add_u32 v102, v108, 7, v102
    v_lshrrev_b32 v106, 1, v106
    v_lshl_add_u32 v106, v104, 1, v106
    v_and_b32 v108, 2, v126
    v_xor_b32 v106, v106, v108
    v_xor_b32 v106, s77, v106
    v_lshl_add_u32 v102, v106, 4, v102
    s_lshl_b32 s12, s78, 3
    s_add_u32 s12, s12, 127232
    v_add_u32 v102, s12, v102
    v_xor_b32 v108, 64, v102
    v_bfe_u32 v106, v127, 4, 1
    v_mul_u32_u24 v103, 14336, v106
    v_bfe_u32 v106, v127, 3, 1
    v_mul_u32_u24 v106, 2304, v106
    v_add_u32 v103, v103, v106
    v_bfe_u32 v106, v127, 2, 1
    v_mul_u32_u24 v106, 576, v106
    v_add_u32 v103, v103, v106
    v_lshl_add_u32 v103, v105, 4, v103
    s_lshl_b32 s12, s76, 6
    s_add_u32 s12, s12, 256
    v_add_u32 v103, s12, v103
    s_mul_i32 s89, s4, 7
    s_add_u32 s89, s89, s5
    s_mul_i32 s89, s89, 49152
    s_lshl_b32 s12, s76, 11
    s_add_u32 s89, s89, s12
    s_add_u32 s89, s89, 0x400000
    v_add_u32 v109, 8192, v122
    s_add_u32 s80, s89, 16384
    s_add_u32 s82, s89, 32768
    s_add_u32 s56, s42, 0x1100000
    s_addc_u32 s57, s43, 0
    s_and_b32 s57, s57, 0xffff
    s_mov_b32 s58, 0x1c0000
    s_mov_b32 s59, 0x20000
    v_lshrrev_b32 v110, 5, v127
    v_bfe_u32 v111, v127, 3, 2
    v_lshl_add_u32 v110, v110, 4, v111
    v_mul_u32_u24 v110, 896, v110
    v_and_b32 v111, 0x70, v122
    v_add_u32 v110, v110, v111
    s_lshl_b32 s80, s7, 7
    s_add_u32 s80, s80, s86
    s_xor_b32 s12, s72, 3
    v_mov_b32 v98, s12
    s_cmp_lg_u32 s3, 7
    s_cbranch_scc1 N7_60
    v_and_b32 v99, 31, v127
    v_max_u32 v99, 4, v99
    v_lshlrev_b32 v99, 7, v99
    s_mov_b32 s75, 65536
LS_61:
    s_sleep 1
    ds_read_b32 v114, v115 offset:0
    s_sub_u32 s75, s75, 1
    s_cmp_eq_u32 s75, 0
    s_cbranch_scc1 LD_62
    s_waitcnt lgkmcnt(0)
    v_cmp_gt_u32 vcc, 3, v114
    s_cbranch_vccnz LS_61
LD_62:
    s_waitcnt lgkmcnt(0)
    buffer_load_dword v99, v99, s[44:47], s86 offen sc1
    s_waitcnt vmcnt(0)
    v_cmp_ne_u32 vcc, s87, v99
    s_cmp_eq_u64 vcc, 0
    s_cselect_b32 s88, 32, 0
N7_60:
    v_lshlrev_b32 v99, 2, v120
    s_mov_b32 s75, 65536
LS_63:
    s_sleep 1
    ds_read_b32 v114, v115 offset:0
    s_sub_u32 s75, s75, 1
    s_cmp_eq_u32 s75, 0
    s_cbranch_scc1 LD_64
    s_waitcnt lgkmcnt(0)
    v_cmp_gt_u32 vcc, 6, v114
    s_cbranch_vccnz LS_63
LD_64:
    s_waitcnt lgkmcnt(0)
    buffer_load_dwordx4 v[28:31], v122, s[44:47], s89 offen offset:0 sc1
    buffer_load_dwordx4 v[32:35], v122, s[44:47], s89 offen offset:1024 sc1
    buffer_load_dwordx4 v[36:39], v109, s[44:47], s89 offen offset:0 sc1
    buffer_load_dwordx4 v[40:43], v109, s[44:47], s89 offen offset:1024 sc1
    buffer_load_dwordx4 v[20:23], v100, s[44:47], s84 offen sc1
    buffer_load_dwordx4 v[24:27], v100, s[44:47], s85 offen sc1
    s_mov_b32 s75, 4096
    s_waitcnt vmcnt(2)
    s_branch TM_66
TT_65:
    s_sleep 2
    buffer_load_dwordx4 v[28:31], v122, s[44:47], s89 offen offset:0 sc1
    buffer_load_dwordx4 v[32:35], v122, s[44:47], s89 offen offset:1024 sc1
    buffer_load_dwordx4 v[36:39], v109, s[44:47], s89 offen offset:0 sc1
    buffer_load_dwordx4 v[40:43], v109, s[44:47], s89 offen offset:1024 sc1
    s_sub_u32 s75, s75, 1
    s_cmp_eq_u32 s75, 0
    s_waitcnt vmcnt(0)
    s_cbranch_scc1 TD_67
TM_66:
    v_xor_b32 v16, v28, v116
    v_xor_b32 v17, v29, v117
    v_bitop3_b32 v16, v30, v118, v16 bitop3:0xbe
    v_bitop3_b32 v17, v31, v119, v17 bitop3:0xbe
    v_bitop3_b32 v16, v32, v116, v16 bitop3:0xbe
    v_bitop3_b32 v17, v33, v117, v17 bitop3:0xbe
    v_bitop3_b32 v16, v34, v118, v16 bitop3:0xbe
    v_bitop3_b32 v17, v35, v119, v17 bitop3:0xbe
    v_bitop3_b32 v16, v36, v116, v16 bitop3:0xbe
    v_bitop3_b32 v17, v37, v117, v17 bitop3:0xbe
    v_bitop3_b32 v16, v38, v118, v16 bitop3:0xbe
    v_bitop3_b32 v17, v39, v119, v17 bitop3:0xbe
    v_bitop3_b32 v16, v40, v116, v16 bitop3:0xbe
    v_bitop3_b32 v17, v41, v117, v17 bitop3:0xbe
    v_bitop3_b32 v16, v42, v118, v16 bitop3:0xbe
    v_bitop3_b32 v17, v43, v119, v17 bitop3:0xbe
    v_or_b32 v16, v16, v17
    v_and_b32 v16, 0x10001, v16
    v_cmp_ne_u32 vcc, 0, v16
    s_cbranch_vccnz TT_65
TD_67:
    s_mov_b64 exec, 1
    s_cmp_lg_u32 s88, 32
    s_cbranch_scc1 SC_68
    buffer_store_dword v98, v99, s[44:47], s80 offen offset:64
SB_69:
    s_mov_b64 exec, -1
    v_pk_add_f16 v28, v28, v36
    v_pk_add_f16 v29, v29, v37
    v_pk_add_f16 v30, v30, v38
    v_pk_add_f16 v31, v31, v39
    v_pk_add_f16 v32, v32, v40
    v_pk_add_f16 v33, v33, v41
    v_pk_add_f16 v34, v34, v42
    v_pk_add_f16 v35, v35, v43
    s_mov_b32 s75, 4096
    s_waitcnt vmcnt(1)
    s_branch TM_71
TT_70:
    s_sleep 4
    buffer_load_dwordx4 v[20:23], v100, s[44:47], s84 offen sc1
    buffer_load_dwordx4 v[24:27], v100, s[44:47], s85 offen sc1
    s_sub_u32 s75, s75, 1
    s_cmp_eq_u32 s75, 0
    s_waitcnt vmcnt(0)
    s_cbranch_scc1 TD_72
TM_71:
    v_xor_b32 v16, v20, v116
    v_xor_b32 v17, v21, v117
    v_bitop3_b32 v16, v22, v118, v16 bitop3:0xbe
    v_bitop3_b32 v17, v23, v119, v17 bitop3:0xbe
    v_bitop3_b32 v16, v24, v116, v16 bitop3:0xbe
    v_bitop3_b32 v17, v25, v117, v17 bitop3:0xbe
    v_bitop3_b32 v16, v26, v118, v16 bitop3:0xbe
    v_bitop3_b32 v17, v27, v119, v17 bitop3:0xbe
    v_or_b32 v16, v16, v17
    v_and_b32 v16, 0x10001, v16
    v_cmp_ne_u32 vcc, 0, v16
    s_cbranch_vccnz TT_70
TD_72:
    ds_write_b128 v101, v[20:23]
    ds_write_b128 v107, v[24:27] offset:1024
    v_mov_b32 v123, 5
    ds_write_b32 v120, v123 offset:32
    s_mov_b32 s75, 65536
LS_73:
    ds_read_b32 v114, v115 offset:32
    s_sub_u32 s75, s75, 1
    s_cmp_eq_u32 s75, 0
    s_cbranch_scc1 LD_74
    s_waitcnt lgkmcnt(0)
    v_cmp_gt_u32 vcc, 5, v114
    s_cbranch_vccnz LS_73
LD_74:
    s_waitcnt lgkmcnt(0)
    ds_read_b64_tr_b16 v[20:21], v102 offset:0
    ds_read_b64_tr_b16 v[22:23], v102 offset:512
    ds_read_b64_tr_b16 v[24:25], v108 offset:0
    ds_read_b64_tr_b16 v[26:27], v108 offset:512
    s_waitcnt lgkmcnt(0)
    v_fma_mix_f32 v0, v20, v80, 0 op_sel:[0,0,0] op_sel_hi:[1,0,0]
    v_fma_mix_f32 v1, v20, v81, 0 op_sel:[1,0,0] op_sel_hi:[1,0,0]
    v_fma_mix_f32 v2, v21, v82, 0 op_sel:[0,0,0] op_sel_hi:[1,0,0]
    v_fma_mix_f32 v3, v21, v83, 0 op_sel:[1,0,0] op_sel_hi:[1,0,0]
    v_fma_mix_f32 v4, v22, v84, 0 op_sel:[0,0,0] op_sel_hi:[1,0,0]
    v_fma_mix_f32 v5, v22, v85, 0 op_sel:[1,0,0] op_sel_hi:[1,0,0]
    v_fma_mix_f32 v6, v23, v86, 0 op_sel:[0,0,0] op_sel_hi:[1,0,0]
    v_fma_mix_f32 v7, v23, v87, 0 op_sel:[1,0,0] op_sel_hi:[1,0,0]
    v_fma_mix_f32 v8, v24, v88, 0 op_sel:[0,0,0] op_sel_hi:[1,0,0]
    v_fma_mix_f32 v9, v24, v89, 0 op_sel:[1,0,0] op_sel_hi:[1,0,0]
    v_fma_mix_f32 v10, v25, v90, 0 op_sel:[0,0,0] op_sel_hi:[1,0,0]
    v_fma_mix_f32 v11, v25, v91, 0 op_sel:[1,0,0] op_sel_hi:[1,0,0]
    v_fma_mix_f32 v12, v26, v92, 0 op_sel:[0,0,0] op_sel_hi:[1,0,0]
    v_fma_mix_f32 v13, v26, v93, 0 op_sel:[1,0,0] op_sel_hi:[1,0,0]
    v_fma_mix_f32 v14, v27, v94, 0 op_sel:[0,0,0] op_sel_hi:[1,0,0]
    v_fma_mix_f32 v15, v27, v95, 0 op_sel:[1,0,0] op_sel_hi:[1,0,0]
    s_mov_b32 s75, 65536
LS_75:
    s_sleep 1
    ds_read_b32 v114, v115 offset:0
    s_sub_u32 s75, s75, 1
    s_cmp_eq_u32 s75, 0
    s_cbranch_scc1 LD_76
    s_waitcnt lgkmcnt(0)
    v_cmp_gt_u32 vcc, 7, v114
    s_cbranch_vccnz LS_75
LD_76:
    s_waitcnt lgkmcnt(0)
    buffer_load_dwordx4 v[44:47], v110, s[68:71], s90 offen sc1
    buffer_load_dwordx4 v[48:51], v110, s[68:71], s91 offen sc1
    buffer_load_dwordx4 v[52:55], v110, s[56:59], s90 offen sc1
    buffer_load_dwordx4 v[56:59], v110, s[56:59], s91 offen sc1
    s_mov_b32 s75, 4096
    s_waitcnt vmcnt(0)
    s_branch TM_78
TT_77:
    s_sleep 2
    buffer_load_dwordx4 v[44:47], v110, s[68:71], s90 offen sc1
    buffer_load_dwordx4 v[48:51], v110, s[68:71], s91 offen sc1
    buffer_load_dwordx4 v[52:55], v110, s[56:59], s90 offen sc1
    buffer_load_dwordx4 v[56:59], v110, s[56:59], s91 offen sc1
    s_sub_u32 s75, s75, 1
    s_cmp_eq_u32 s75, 0
    s_waitcnt vmcnt(0)
    s_cbranch_scc1 TD_79
TM_78:
    v_xor_b32 v16, v44, v116
    v_xor_b32 v17, v45, v117
    v_bitop3_b32 v16, v46, v118, v16 bitop3:0xbe
    v_bitop3_b32 v17, v47, v119, v17 bitop3:0xbe
    v_bitop3_b32 v16, v48, v116, v16 bitop3:0xbe
    v_bitop3_b32 v17, v49, v117, v17 bitop3:0xbe
    v_bitop3_b32 v16, v50, v118, v16 bitop3:0xbe
    v_bitop3_b32 v17, v51, v119, v17 bitop3:0xbe
    v_bitop3_b32 v16, v52, v116, v16 bitop3:0xbe
    v_bitop3_b32 v17, v53, v117, v17 bitop3:0xbe
    v_bitop3_b32 v16, v54, v118, v16 bitop3:0xbe
    v_bitop3_b32 v17, v55, v119, v17 bitop3:0xbe
    v_bitop3_b32 v16, v56, v116, v16 bitop3:0xbe
    v_bitop3_b32 v17, v57, v117, v17 bitop3:0xbe
    v_bitop3_b32 v16, v58, v118, v16 bitop3:0xbe
    v_bitop3_b32 v17, v59, v119, v17 bitop3:0xbe
    v_or_b32 v16, v16, v17
    v_and_b32 v16, 0x10001, v16
    v_cmp_ne_u32 vcc, 0, v16
    s_cbranch_vccnz TT_77
TD_79:
    v_pk_add_f16 v44, v44, v52
    v_pk_add_f16 v45, v45, v53
    v_pk_add_f16 v46, v46, v54
    v_pk_add_f16 v47, v47, v55
    v_pk_add_f16 v48, v48, v56
    v_pk_add_f16 v49, v49, v57
    v_pk_add_f16 v50, v50, v58
    v_pk_add_f16 v51, v51, v59
    v_pk_add_f16 v44, v44, v28
    v_pk_add_f16 v45, v45, v29
    v_pk_add_f16 v46, v46, v30
    v_pk_add_f16 v47, v47, v31
    v_pk_add_f16 v48, v48, v32
    v_pk_add_f16 v49, v49, v33
    v_pk_add_f16 v50, v50, v34
    v_pk_add_f16 v51, v51, v35
    v_xor_b32 v116, 0x10001, v116
    v_xor_b32 v117, 0x10001, v117
    v_xor_b32 v118, 0x10001, v118
    v_xor_b32 v119, 0x10001, v119
    v_fma_mix_f32 v0, v44, v96, v0 op_sel:[0,0,0] op_sel_hi:[1,0,0]
    v_fma_mix_f32 v1, v44, v96, v1 op_sel:[1,0,0] op_sel_hi:[1,0,0]
    v_fma_mix_f32 v2, v45, v96, v2 op_sel:[0,0,0] op_sel_hi:[1,0,0]
    v_fma_mix_f32 v3, v45, v96, v3 op_sel:[1,0,0] op_sel_hi:[1,0,0]
    v_fma_mix_f32 v4, v46, v96, v4 op_sel:[0,0,0] op_sel_hi:[1,0,0]
    v_fma_mix_f32 v5, v46, v96, v5 op_sel:[1,0,0] op_sel_hi:[1,0,0]
    v_fma_mix_f32 v6, v47, v96, v6 op_sel:[0,0,0] op_sel_hi:[1,0,0]
    v_fma_mix_f32 v7, v47, v96, v7 op_sel:[1,0,0] op_sel_hi:[1,0,0]
    v_fma_mix_f32 v8, v48, v97, v8 op_sel:[0,0,0] op_sel_hi:[1,0,0]
    v_fma_mix_f32 v9, v48, v97, v9 op_sel:[1,0,0] op_sel_hi:[1,0,0]
    v_fma_mix_f32 v10, v49, v97, v10 op_sel:[0,0,0] op_sel_hi:[1,0,0]
    v_fma_mix_f32 v11, v49, v97, v11 op_sel:[1,0,0] op_sel_hi:[1,0,0]
    v_fma_mix_f32 v12, v50, v97, v12 op_sel:[0,0,0] op_sel_hi:[1,0,0]
    v_fma_mix_f32 v13, v50, v97, v13 op_sel:[1,0,0] op_sel_hi:[1,0,0]
    v_fma_mix_f32 v14, v51, v97, v14 op_sel:[0,0,0] op_sel_hi:[1,0,0]
    v_fma_mix_f32 v15, v51, v97, v15 op_sel:[1,0,0] op_sel_hi:[1,0,0]
    s_mov_b32 s75, 65536
LS_80:
    s_sleep 1
    ds_read_b32 v114, v115 offset:0
    s_sub_u32 s75, s75, 1
    s_cmp_eq_u32 s75, 0
    s_cbranch_scc1 LD_81
    s_waitcnt lgkmcnt(0)
    v_cmp_gt_u32 vcc, 8, v114
    s_cbranch_vccnz LS_80
LD_81:
    s_waitcnt lgkmcnt(0)
    buffer_load_dwordx4 v[60:63], v122, s[44:47], s89 offen offset:0 sc1
    buffer_load_dwordx4 v[64:67], v122, s[44:47], s89 offen offset:1024 sc1
    buffer_load_dwordx4 v[68:71], v109, s[44:47], s89 offen offset:0 sc1
    buffer_load_dwordx4 v[72:75], v109, s[44:47], s89 offen offset:1024 sc1
    s_mov_b32 s75, 65536
LS_82:
    s_sleep 1
    ds_read_b32 v114, v115 offset:0
    s_sub_u32 s75, s75, 1
    s_cmp_eq_u32 s75, 0
    s_cbranch_scc1 LD_83
    s_waitcnt lgkmcnt(0)
    v_cmp_gt_u32 vcc, 9, v114
    s_cbranch_vccnz LS_82
LD_83:
    s_waitcnt lgkmcnt(0)
    ds_read_b128 v[28:31], v103 offset:0
    ds_read_b128 v[32:35], v103 offset:1152
    ds_read_b128 v[36:39], v103 offset:28672
    ds_read_b128 v[40:43], v103 offset:29824
    ds_read_b128 v[80:83], v103 offset:4608
    ds_read_b128 v[84:87], v103 offset:5760
    ds_read_b128 v[88:91], v103 offset:33280
    ds_read_b128 v[92:95], v103 offset:34432
    buffer_load_dwordx4 v[44:47], v122, s[44:47], s89 offen offset:0 sc1
    buffer_load_dwordx4 v[48:51], v122, s[44:47], s89 offen offset:1024 sc1
    buffer_load_dwordx4 v[52:55], v109, s[44:47], s89 offen offset:0 sc1
    buffer_load_dwordx4 v[56:59], v109, s[44:47], s89 offen offset:1024 sc1
    s_waitcnt lgkmcnt(4)
    v_add_f32 v28, v28, v36
    v_add_f32 v29, v29, v37
    v_add_f32 v30, v30, v38
    v_add_f32 v31, v31, v39
    v_add_f32 v32, v32, v40
    v_add_f32 v33, v33, v41
    v_add_f32 v34, v34, v42
    v_add_f32 v35, v35, v43
    v_fma_f32 v0, v28, v96, v0
    v_fma_f32 v1, v29, v96, v1
    v_fma_f32 v2, v30, v96, v2
    v_fma_f32 v3, v31, v96, v3
    v_fma_f32 v4, v32, v96, v4
    v_fma_f32 v5, v33, v96, v5
    v_fma_f32 v6, v34, v96, v6
    v_fma_f32 v7, v35, v96, v7
    s_waitcnt lgkmcnt(0)
    v_add_f32 v80, v80, v88
    v_add_f32 v81, v81, v89
    v_add_f32 v82, v82, v90
    v_add_f32 v83, v83, v91
    v_add_f32 v84, v84, v92
    v_add_f32 v85, v85, v93
    v_add_f32 v86, v86, v94
    v_add_f32 v87, v87, v95
    v_fma_f32 v8, v80, v97, v8
    v_fma_f32 v9, v81, v97, v9
    v_fma_f32 v10, v82, v97, v10
    v_fma_f32 v11, v83, v97, v11
    v_fma_f32 v12, v84, v97, v12
    v_fma_f32 v13, v85, v97, v13
    v_fma_f32 v14, v86, v97, v14
    v_fma_f32 v15, v87, v97, v15
    s_mov_b32 s75, 4096
QT_84:
    s_waitcnt vmcnt(4)
    v_xor_b32 v16, v60, v116
    v_xor_b32 v17, v61, v117
    v_bitop3_b32 v16, v62, v118, v16 bitop3:0xbe
    v_bitop3_b32 v17, v63, v119, v17 bitop3:0xbe
    v_bitop3_b32 v16, v64, v116, v16 bitop3:0xbe
    v_bitop3_b32 v17, v65, v117, v17 bitop3:0xbe
    v_bitop3_b32 v16, v66, v118, v16 bitop3:0xbe
    v_bitop3_b32 v17, v67, v119, v17 bitop3:0xbe
    v_bitop3_b32 v16, v68, v116, v16 bitop3:0xbe
    v_bitop3_b32 v17, v69, v117, v17 bitop3:0xbe
    v_bitop3_b32 v16, v70, v118, v16 bitop3:0xbe
    v_bitop3_b32 v17, v71, v119, v17 bitop3:0xbe
    v_bitop3_b32 v16, v72, v116, v16 bitop3:0xbe
    v_bitop3_b32 v17, v73, v117, v17 bitop3:0xbe
    v_bitop3_b32 v16, v74, v118, v16 bitop3:0xbe
    v_bitop3_b32 v17, v75, v119, v17 bitop3:0xbe
    v_or_b32 v16, v16, v17
    v_and_b32 v16, 0x10001, v16
    v_cmp_ne_u32 vcc, 0, v16
    s_cbranch_vccz QA_85
    buffer_load_dwordx4 v[60:63], v122, s[44:47], s89 offen offset:0 sc1
    buffer_load_dwordx4 v[64:67], v122, s[44:47], s89 offen offset:1024 sc1
    buffer_load_dwordx4 v[68:71], v109, s[44:47], s89 offen offset:0 sc1
    buffer_load_dwordx4 v[72:75], v109, s[44:47], s89 offen offset:1024 sc1
    s_waitcnt vmcnt(4)
    v_xor_b32 v16, v44, v116
    v_xor_b32 v17, v45, v117
    v_bitop3_b32 v16, v46, v118, v16 bitop3:0xbe
    v_bitop3_b32 v17, v47, v119, v17 bitop3:0xbe
    v_bitop3_b32 v16, v48, v116, v16 bitop3:0xbe
    v_bitop3_b32 v17, v49, v117, v17 bitop3:0xbe
    v_bitop3_b32 v16, v50, v118, v16 bitop3:0xbe
    v_bitop3_b32 v17, v51, v119, v17 bitop3:0xbe
    v_bitop3_b32 v16, v52, v116, v16 bitop3:0xbe
    v_bitop3_b32 v17, v53, v117, v17 bitop3:0xbe
    v_bitop3_b32 v16, v54, v118, v16 bitop3:0xbe
    v_bitop3_b32 v17, v55, v119, v17 bitop3:0xbe
    v_bitop3_b32 v16, v56, v116, v16 bitop3:0xbe
    v_bitop3_b32 v17, v57, v117, v17 bitop3:0xbe
    v_bitop3_b32 v16, v58, v118, v16 bitop3:0xbe
    v_bitop3_b32 v17, v59, v119, v17 bitop3:0xbe
    v_or_b32 v16, v16, v17
    v_and_b32 v16, 0x10001, v16
    v_cmp_ne_u32 vcc, 0, v16
    s_cbranch_vccz QB_86
    buffer_load_dwordx4 v[44:47], v122, s[44:47], s89 offen offset:0 sc1
    buffer_load_dwordx4 v[48:51], v122, s[44:47], s89 offen offset:1024 sc1
    buffer_load_dwordx4 v[52:55], v109, s[44:47], s89 offen offset:0 sc1
    buffer_load_dwordx4 v[56:59], v109, s[44:47], s89 offen offset:1024 sc1
    s_sub_u32 s75, s75, 1
    s_cmp_lg_u32 s75, 0
    s_cbranch_scc1 QT_84
QB_86:
    v_pk_add_f16 v28, v44, v52
    v_pk_add_f16 v29, v45, v53
    v_pk_add_f16 v30, v46, v54
    v_pk_add_f16 v31, v47, v55
    v_pk_add_f16 v32, v48, v56
    v_pk_add_f16 v33, v49, v57
    v_pk_add_f16 v34, v50, v58
    v_pk_add_f16 v35, v51, v59
    s_branch QF_87
QA_85:
    v_pk_add_f16 v28, v60, v68
    v_pk_add_f16 v29, v61, v69
    v_pk_add_f16 v30, v62, v70
    v_pk_add_f16 v31, v63, v71
    v_pk_add_f16 v32, v64, v72
    v_pk_add_f16 v33, v65, v73
    v_pk_add_f16 v34, v66, v74
    v_pk_add_f16 v35, v67, v75
QF_87:
    v_fma_mix_f32 v0, v28, v96, v0 op_sel:[0,0,0] op_sel_hi:[1,0,0]
    v_fma_mix_f32 v1, v28, v96, v1 op_sel:[1,0,0] op_sel_hi:[1,0,0]
    v_fma_mix_f32 v2, v29, v96, v2 op_sel:[0,0,0] op_sel_hi:[1,0,0]
    v_fma_mix_f32 v3, v29, v96, v3 op_sel:[1,0,0] op_sel_hi:[1,0,0]
    v_fma_mix_f32 v4, v30, v96, v4 op_sel:[0,0,0] op_sel_hi:[1,0,0]
    v_fma_mix_f32 v5, v30, v96, v5 op_sel:[1,0,0] op_sel_hi:[1,0,0]
    v_fma_mix_f32 v6, v31, v96, v6 op_sel:[0,0,0] op_sel_hi:[1,0,0]
    v_fma_mix_f32 v7, v31, v96, v7 op_sel:[1,0,0] op_sel_hi:[1,0,0]
    v_cvt_pk_bf16_f32 v20, v0, v1
    v_cvt_pk_bf16_f32 v21, v2, v3
    v_cvt_pk_bf16_f32 v22, v4, v5
    v_cvt_pk_bf16_f32 v23, v6, v7
    buffer_store_dwordx4 v[20:23], v113, s[68:71], s90 offen
    v_fma_mix_f32 v8, v32, v97, v8 op_sel:[0,0,0] op_sel_hi:[1,0,0]
    v_fma_mix_f32 v9, v32, v97, v9 op_sel:[1,0,0] op_sel_hi:[1,0,0]
    v_fma_mix_f32 v10, v33, v97, v10 op_sel:[0,0,0] op_sel_hi:[1,0,0]
    v_fma_mix_f32 v11, v33, v97, v11 op_sel:[1,0,0] op_sel_hi:[1,0,0]
    v_fma_mix_f32 v12, v34, v97, v12 op_sel:[0,0,0] op_sel_hi:[1,0,0]
    v_fma_mix_f32 v13, v34, v97, v13 op_sel:[1,0,0] op_sel_hi:[1,0,0]
    v_fma_mix_f32 v14, v35, v97, v14 op_sel:[0,0,0] op_sel_hi:[1,0,0]
    v_fma_mix_f32 v15, v35, v97, v15 op_sel:[1,0,0] op_sel_hi:[1,0,0]
    v_cvt_pk_bf16_f32 v24, v8, v9
    v_cvt_pk_bf16_f32 v25, v10, v11
    v_cvt_pk_bf16_f32 v26, v12, v13
    v_cvt_pk_bf16_f32 v27, v14, v15
    buffer_store_dwordx4 v[24:27], v113, s[68:71], s91 offen
    s_waitcnt vmcnt(2)
CE_57:
    s_endpgm
L_CX7:
    s_mov_b32 s60, s40
    s_and_b32 s61, s41, 0xffff
    s_mov_b32 s62, 0x100
    s_mov_b32 s63, 0x20000
    s_cmp_lt_u32 s7, 4
    s_cbranch_scc1 L_END
    s_mov_b32 s44, s42
    s_and_b32 s45, s43, 0xffff
    s_mov_b32 s46, 0x3000000
    s_mov_b32 s47, 0x20000
    s_mov_b32 s68, s38
    s_and_b32 s69, s39, 0xffff
    s_mov_b32 s70, 0x1c0000
    s_mov_b32 s71, 0x20000
    s_barrier
    ds_write_b32 v120, v121 offset:16
    s_sleep 8
    v_mov_b32 v98, 0
    v_lshlrev_b32 v119, 3, v104
    s_mov_b32 s75, 4096
    s_branch EM_89
EP_88:
    buffer_load_dword v98, v124, s[60:63], 0 offen offset:224 sc1
    s_waitcnt vmcnt(0)
EM_89:
    v_readfirstlane_b32 s72, v98
    s_sub_u32 s75, s75, 1
    s_cmp_eq_u32 s75, 0
    s_cbranch_scc1 ED_90
    s_cmp_lg_u32 s72, 0
    s_cbranch_scc0 EP_88
ED_90:
    s_xor_b32 s87, s87, s72
    s_cmp_lg_u32 s76, 0
    s_cbranch_scc1 NR_91
    v_mov_b32 v64, s72
    ds_write_b32 v124, v64 offset:68
    s_lshl_b32 s12, s7, 7
    s_add_u32 s12, s12, s86
    v_mov_b32 v64, s87
    s_mov_b64 exec, 0xff
    buffer_store_dwordx4 v[64:67], v122, s[44:47], s12 offen
    s_mov_b64 exec, -1
NR_91:
    v_bfe_u32 v119, s72, v119, 8
    v_lshl_or_b32 v119, v119, 15, v119
    v_and_b32 v116, 0x10001, v119
    v_lshrrev_b32 v117, 2, v119
    v_lshrrev_b32 v118, 4, v119
    v_lshrrev_b32 v119, 6, v119
    v_and_b32 v117, 0x10001, v117
    v_and_b32 v118, 0x10001, v118
    v_and_b32 v119, 0x10001, v119
    s_branch L_CGATE
KF_49:
    buffer_load_dwordx4 v[8:11], v98, s[44:47], s80 offen offset:0 sc1
    buffer_load_dwordx4 v[12:15], v98, s[44:47], s80 offen offset:1024 sc1
    s_waitcnt vmcnt(0)
    buffer_store_dwordx4 v[8:11], v98, s[44:47], s80 offen offset:0 sc1
    buffer_store_dwordx4 v[12:15], v98, s[44:47], s80 offen offset:1024 sc1
    s_waitcnt vmcnt(0)
    s_branch KB_50
KF_55:
    buffer_load_dwordx4 v[32:35], v98, s[44:47], s80 offen offset:0 sc1
    buffer_load_dwordx4 v[36:39], v98, s[44:47], s80 offen offset:1024 sc1
    s_waitcnt vmcnt(0)
    buffer_store_dwordx4 v[32:35], v98, s[44:47], s80 offen offset:0 sc1
    buffer_store_dwordx4 v[36:39], v98, s[44:47], s80 offen offset:1024 sc1
    s_waitcnt vmcnt(0)
    s_branch KB_56
SC_68:
    buffer_store_dword v98, v99, s[44:47], s80 offen offset:64 sc1
    s_branch SB_69
L_END:
    s_endpgm
.section .rodata,"a"
.p2align 6
.amdhsa_kernel gated_mix__ssm_conv_h3__dense_activation_mish__prompt_kernel
  .amdhsa_next_free_vgpr 256
  .amdhsa_next_free_sgpr 102
  .amdhsa_accum_offset 128
  .amdhsa_group_segment_fixed_size 0
  .amdhsa_kernarg_size 112
  .amdhsa_user_sgpr_count 2
  .amdhsa_user_sgpr_kernarg_segment_ptr 1
  .amdhsa_system_sgpr_workgroup_id_x 1
.end_amdhsa_kernel
```
